```python
import torch

def _softmax(x, axis=-1):
    return torch.softmax(x, dim=axis)
def _gelu(x):
    return torch.nn.functional.gelu(x, approximate="tanh")
def _silu(x):
    return torch.nn.functional.silu(x)
def _sigmoid(x):
    return torch.sigmoid(x)
def _layernorm(x, axis=-1, eps=1e-5):
    m = x.mean(dim=axis, keepdim=True)
    v = x.var(dim=axis, keepdim=True, unbiased=False)
    return (x - m) / torch.sqrt(v + eps)
def _scatter_add(tgt, idx, src, axis=0):
    return tgt.clone().index_add_(axis, idx, src)
def _segment_sum(src, seg, n):
    out = torch.zeros((n,) + src.shape[1:], dtype=src.dtype)
    return out.index_add_(0, seg, src)
def _pad(x, pw):
    flat = tuple(v for pair in reversed(pw) for v in pair)
    return torch.nn.functional.pad(x, flat)

kernel_name = 'standalone__edge_featured_mpnn_mpnn__graph'

def setup_inputs():

    _w = (lambda a: (lambda t: t.to(torch.bfloat16) if t.is_floating_point() else t)(torch.as_tensor(a)))
    N, deg, D, De = 10000, 32, 128, max(16, 1)
    E = N * deg
    H = 2 * D
    return {
        "x": _w((lambda *s: torch.randn(*s, dtype=torch.bfloat16) * 0.05)(N, D)),
        "e_attr": _w((lambda *s: torch.randn(*s, dtype=torch.bfloat16) * 0.8)(E, De)),
        "src": _w((lambda lo, hi, *s: torch.randint(lo, hi, s))(0, N, E).to(torch.int64)),
        "dst": _w((lambda lo, hi, *s: torch.randint(lo, hi, s))(0, N, E).to(torch.int64)),
        "w1": _w((lambda *s: torch.randn(*s, dtype=torch.bfloat16) * 0.8)(2 * D + De, H) * (1.0 / (2 * D + De) ** 0.5)),
        "b1": _w((lambda *s: torch.randn(*s, dtype=torch.bfloat16) * 0.4)(H) * 0.01),
        "w2": _w((lambda *s: torch.randn(*s, dtype=torch.bfloat16) * 0.05)(H, D) * (1.0 / H ** 0.5)),
        "b2": _w((lambda *s: torch.randn(*s, dtype=torch.bfloat16) * 0.05)(D) * 0.01),
    }

def reference(x, e_attr, src, dst, w1, b1, w2, b2):
    N, D = x.shape
    h_src = x[src]
    h_dst = x[dst]
    m_in = torch.concatenate([h_src, h_dst, e_attr], axis=-1)
    h = _silu(m_in @ w1 + b1)
    msg = h @ w2 + b2
    return _segment_sum(msg, dst, N)
```

```asm
; @launch grid=(253,1,1) block=(512,1,1) lds=163456
    .amdgcn_target "amdgcn-amd-amdhsa--gfx950"
    .text
    .globl standalone__edge_featured_mpnn_mpnn__graph_kernel
    .p2align 8
    .type standalone__edge_featured_mpnn_mpnn__graph_kernel,@function
standalone__edge_featured_mpnn_mpnn__graph_kernel:
    s_cmp_ge_u32 s2, 253
    s_cbranch_scc1 L_done
    s_load_dwordx16 s[4:19], s[0:1], 0
    s_load_dwordx2 s[20:21], s[0:1], 80
    s_load_dwordx2 s[24:25], s[0:1], 64
    s_cmp_ge_u32 s2, 256
    s_cbranch_scc1 L_nocpf
    s_getpc_b64 s[96:97]
    v_lshlrev_b32 v1, 7, v0
    v_min_u32 v1, 12288, v1
    v_cmp_gt_u32 vcc, 128, v0
    s_mov_b64 exec, vcc
    s_cbranch_execz L_nocpf
    global_load_dword v250, v1, s[96:97]
L_nocpf:
    s_mov_b64 exec, -1
    v_lshrrev_b32 v1, 6, v0
    v_and_b32 v2, 63, v0
    v_lshrrev_b32 v7, 2, v0
    v_readfirstlane_b32 s22, v1
    v_lshrrev_b32 v3, 4, v2
    v_and_b32 v4, 15, v2
    v_and_b32 v5, 31, v2
    v_lshrrev_b32 v6, 5, v2
    v_lshlrev_b32 v1, 4, v2
    v_lshlrev_b32 v255, 2, v0
    s_mov_b32 s73, 0
    s_mov_b32 s82, 0
    s_and_b32 s26, s22, 3
    s_lshr_b32 s27, s22, 2
    s_lshr_b32 s83, s2, 1
    s_and_b32 s89, s2, 7
    s_lshr_b32 s88, s2, 3
    s_xor_b32 s88, s88, s2
    s_and_b32 s88, s88, 1
    s_and_b32 s75, s2, 1
    s_lshl_b32 s42, s26, 2
    v_add_u32 v82, s42, v3
    v_xor_b32 v82, v82, v4
    v_lshlrev_b32 v82, 4, v82
    v_lshl_add_u32 v82, v3, 8, v82
    v_lshrrev_b32 v83, 1, v5
    v_xor_b32 v83, v83, v6
    v_lshlrev_b32 v83, 5, v83
    v_and_b32 v196, 1, v2
    v_lshl_add_u32 v83, v196, 4, v83
    v_lshl_add_u32 v83, v6, 9, v83
    v_xor_b32 v252, 64, v83
    v_xor_b32 v253, 0x80, v83
    v_xor_b32 v254, 0xc0, v83
    s_lshl_b32 s46, s22, 10
    s_lshl_b32 s47, s22, 13
    s_add_u32 s51, s47, 97920
    s_add_u32 s50, s51, 4096
    v_mov_b32 v200, 1
    s_waitcnt lgkmcnt(0)
    s_cmp_ge_u32 s2, 250
    s_cbranch_scc1 L_prep
    s_cmp_eq_u32 s88, 0
    s_cbranch_scc1 L_nosl
    s_mov_b32 s36, s10
    s_mov_b32 s37, s11
    s_mov_b32 s38, 1280000
    s_mov_b32 s39, 0x00020000
    s_mov_b32 s40, s8
    s_mov_b32 s41, s9
    s_mov_b32 s42, 1280000
    s_mov_b32 s43, 0x00020000
    s_mul_i32 s44, s83, 10240
    s_add_u32 s48, s44, 8192
    v_lshlrev_b32 v119, 4, v0
    buffer_load_dwordx4 v[108:111], v119, s[36:39], s44 offen nt
    buffer_load_dword v112, v255, s[36:39], s48 offen nt
    buffer_load_dwordx4 v[114:117], v119, s[40:43], s44 offen nt
    buffer_load_dword v118, v255, s[40:43], s48 offen nt
    v_mov_b32 v120, -1
    v_mov_b32 v121, -1
    v_mov_b32 v122, -1
    v_mov_b32 v123, -1
    v_mov_b32 v113, 0
    v_min_u32 v124, 1020, v255
    ds_write_b128 v119, v[120:123] offset:32384
    ds_write_b128 v119, v[120:123] offset:40576
    ds_write_b128 v119, v[120:123] offset:48768
    ds_write_b128 v119, v[120:123] offset:56960
    ds_write_b32 v124, v113 offset:30720
    s_branch L_xdma
L_nosl:
    s_mov_b32 s52, s12
    s_mov_b32 s53, s13
    s_mov_b32 s54, 139264
    s_mov_b32 s55, 0x00020000
    s_lshr_b32 s44, s2, 4
    s_and_b32 s44, s44, 7
    s_cmp_lg_u32 s44, s22
    s_cbranch_scc1 L_nosl2
    s_add_u32 s44, s47, 65536
    v_lshlrev_b32 v249, 7, v2
    buffer_load_dword v250, v249, s[52:55], s44 offen
L_nosl2:
    s_mov_b32 s56, s4
    s_mov_b32 s57, s5
    s_mov_b32 s58, 2560000
    s_mov_b32 s59, 0x00020000
    s_mul_i32 s45, s2, 10240
    s_add_u32 s45, s45, s46
    s_add_u32 m0, s46, 0
    s_nop 0
    buffer_load_dwordx4 v82, s[56:59], s45 offen nt lds
    s_cmp_ge_u32 s22, 2
    s_cbranch_scc1 L_nox0
    s_add_u32 m0, s46, 8192
    s_add_u32 s45, s45, 8192
    buffer_load_dwordx4 v82, s[56:59], s45 offen nt lds
L_nox0:
    s_add_u32 m0, s47, 97920
    s_add_u32 s44, s47, 0
    buffer_load_dwordx4 v83, s[52:55], s44 offen offset:0 lds
    buffer_load_dwordx4 v252, s[52:55], s44 offen offset:1024 lds
    buffer_load_dwordx4 v83, s[52:55], s44 offen offset:2048 lds
    buffer_load_dwordx4 v252, s[52:55], s44 offen offset:3072 lds
    s_add_u32 m0, s47, 102016
    s_add_u32 s44, s47, 4096
    buffer_load_dwordx4 v253, s[52:55], s44 offen offset:0 lds
    buffer_load_dwordx4 v254, s[52:55], s44 offen offset:1024 lds
    buffer_load_dwordx4 v253, s[52:55], s44 offen offset:2048 lds
    buffer_load_dwordx4 v254, s[52:55], s44 offen offset:3072 lds
    s_branch L_nox
L_xdma:
    s_mov_b32 s56, s4
    s_mov_b32 s57, s5
    s_mov_b32 s58, 2560000
    s_mov_b32 s59, 0x00020000
    s_mul_i32 s45, s2, 10240
    s_add_u32 s45, s45, s46
    s_add_u32 m0, s46, 0
    s_nop 0
    buffer_load_dwordx4 v82, s[56:59], s45 offen nt lds
    s_cmp_ge_u32 s22, 2
    s_cbranch_scc1 L_nox
    s_add_u32 m0, s46, 8192
    s_add_u32 s45, s45, 8192
    buffer_load_dwordx4 v82, s[56:59], s45 offen nt lds
L_nox:
L_static:
    s_add_u32 s84, s20, 9592832
    s_addc_u32 s85, s21, 0
    s_load_dwordx2 s[86:87], s[84:85], 0
    s_add_u32 s76, s20, 9568256
    s_addc_u32 s77, s21, 0
    s_mov_b32 s78, 32768
    s_mov_b32 s79, 0x00020000
    s_mov_b32 s56, s14
    s_mov_b32 s57, s15
    s_mov_b32 s58, 512
    s_mov_b32 s59, 0x00020000
    s_lshl_b32 s44, s22, 6
    v_lshlrev_b32 v197, 3, v3
    buffer_load_dwordx2 v[206:207], v197, s[56:59], s44 offen
    buffer_load_dwordx2 v[208:209], v197, s[56:59], s44 offen offset:32
    s_mov_b32 s56, s18
    s_mov_b32 s57, s19
    s_mov_b32 s58, 256
    s_mov_b32 s59, 0x00020000
    s_lshl_b32 s44, s22, 5
    buffer_load_dwordx2 v[70:71], v197, s[56:59], s44 offen
    v_mul_u32_u24 v7, 2560, v7
    v_lshlrev_b32 v79, 5, v0
    s_lshl_b32 s95, s2, 14
    v_cmp_gt_u32 vcc, 500, v0
    s_mov_b64 s[96:97], vcc
    s_mov_b32 s28, s20
    s_and_b32 s29, s21, 0xffff
    s_or_b32 s29, s29, 33554432
    s_mov_b32 s30, 10000
    s_mov_b32 s31, 0x00020000
    s_mov_b32 s32, s6
    s_and_b32 s33, s7, 0xffff
    s_or_b32 s33, s33, 2097152
    s_mov_b32 s34, 320000
    s_mov_b32 s35, 0x00020000
    v_and_b32 v196, 1, v5
    v_lshlrev_b32 v196, 4, v196
    v_mov_b32 v197, 0x3f80
    v_lshlrev_b32 v199, v196, v197
    v_lshlrev_b32 v197, 2, v6
    v_lshrrev_b32 v198, 1, v5
    v_xor_b32 v197, v197, v198
    v_cmp_eq_u32 s[60:61], 0, v197
    v_cmp_eq_u32 s[62:63], 1, v197
    v_cmp_eq_u32 s[64:65], 2, v197
    v_cmp_eq_u32 s[66:67], 3, v197
    v_cndmask_b32 v16, 0, v199, s[60:61]
    v_cndmask_b32 v17, 0, v199, s[62:63]
    v_cndmask_b32 v18, 0, v199, s[64:65]
    v_cndmask_b32 v19, 0, v199, s[66:67]
    v_cmp_eq_u32 s[60:61], 8, v197
    v_cmp_eq_u32 s[62:63], 9, v197
    v_cmp_eq_u32 s[64:65], 10, v197
    v_cmp_eq_u32 s[66:67], 11, v197
    v_cndmask_b32 v20, 0, v199, s[60:61]
    v_cndmask_b32 v21, 0, v199, s[62:63]
    v_cndmask_b32 v22, 0, v199, s[64:65]
    v_cndmask_b32 v23, 0, v199, s[66:67]
    v_bfe_u32 v197, v5, 2, 1
    v_cmp_eq_u32 vcc, v197, v6
    v_and_b32 v197, 4, v5
    v_mov_b32 v25, 0
    v_cndmask_b32 v28, 31, v196, vcc
    v_mov_b32 v27, 0
    v_mov_b32 v29, 0
    v_lshlrev_b32 v199, 2, v197
    v_and_b32 v198, 1, v5
    v_lshl_or_b32 v199, v198, 3, v199
    v_lshrrev_b32 v196, 2, v5
    v_and_or_b32 v199, v196, 6, v199
    v_bfe_u32 v196, v5, 1, 1
    v_or_b32 v199, v199, v196
    s_lshl_b32 s23, s27, 13
    s_add_u32 s23, s23, 17792
    v_xor_b32 v198, v198, v6
    v_lshl_add_u32 v81, v198, 4, s23
    v_and_b32 v196, 7, v199
    v_lshl_add_u32 v81, v196, 5, v81
    v_lshrrev_b32 v196, 3, v199
    v_lshl_add_u32 v81, v196, 10, v81
    s_lshl_b32 s48, s26, 10
    s_add_u32 s23, s23, s48
    s_mul_i32 s48, s27, 7680
    s_mul_i32 s49, s27, 960
    s_add_u32 s49, s49, 15360
    v_lshrrev_b32 v196, 3, v2
    v_lshl_add_u32 v34, v196, 3, s48
    v_lshl_add_u32 v35, v199, 3, s48
    s_lshl_b32 s60, s26, 6
    s_add_u32 s48, s48, s60
    v_lshrrev_b32 v196, 1, v4
    v_lshl_add_u32 v80, v196, 3, s48
    v_lshl_add_u32 v80, v3, 8, v80
    v_lshrrev_b32 v196, 2, v4
    v_and_b32 v197, 1, v196
    v_lshl_add_u32 v197, v6, 1, v197
    v_lshl_add_u32 v36, v197, 2, s49
    v_lshl_add_u32 v37, v6, 3, s49
    v_and_b32 v197, 1, v3
    v_and_b32 v198, 3, v2
    s_lshl_b32 s48, s26, 7
    s_add_u32 s49, s48, 1024
    v_lshl_add_u32 v31, v197, 5, s49
    v_lshl_add_u32 v31, v198, 3, v31
    v_lshrrev_b32 v196, 3, v4
    v_lshl_add_u32 v31, v196, 6, v31
    v_mov_b32 v38, 1024
    v_mov_b32 v39, 1024
    v_mov_b32 v40, 128
    v_mov_b32 v41, 128
    s_lshl_b32 s49, s26, 8
    v_lshl_add_u32 v42, v5, 3, s49
    v_mov_b32 v43, v42
    v_xor_b32 v196, s26, v2
    v_and_b32 v196, 1, v196
    v_lshlrev_b32 v47, 4, v196
    v_mov_b32 v67, v47
    v_and_b32 v196, 7, v2
    v_xor_b32 v196, v196, v3
    v_lshlrev_b32 v196, 4, v196
    v_xor_b32 v197, 64, v196
    s_add_u32 s49, s48, 4096
    v_add_u32 v49, s49, v196
    v_mov_b32 v93, v49
    v_mov_b32 v101, v49
    s_add_u32 s49, s48, 3072
    v_add_u32 v51, s49, v197
    v_mov_b32 v95, v51
    v_mov_b32 v103, v51
    s_add_u32 s49, s48, 2048
    v_add_u32 v53, s49, v196
    v_mov_b32 v97, v53
    v_mov_b32 v105, v53
    s_add_u32 s49, s48, 1024
    v_add_u32 v55, s49, v197
    v_mov_b32 v99, v55
    v_mov_b32 v107, v55
    v_bfe_u32 v196, v199, 1, 3
    v_xor_b32 v196, v196, v6
    v_lshlrev_b32 v196, 4, v196
    v_lshl_add_u32 v196, v199, 7, v196
    v_add_u32 v196, s51, v196
    v_xor_b32 v56, 0, v196
    v_xor_b32 v57, 32, v196
    v_xor_b32 v58, 64, v196
    v_xor_b32 v59, 96, v196
    v_mov_b32 v201, 0
    v_lshlrev_b64 v[202:203], v2, v[200:201]
    v_min_u32 v201, 39, v2
    v_lshlrev_b32 v201, 5, v201
    v_mul_u32_u24 v204, 1552, v2
    v_add_u32 v204, 35760, v204
    v_lshlrev_b32 v205, 3, v4
    v_mov_b32 v72, 0
    v_mov_b32 v73, 0
    v_mov_b32 v68, 1.0
    v_mov_b32 v69, 1.0
    v_mov_b32 v188, -1
    v_mov_b32 v189, -1
    v_mov_b32 v190, -1
    v_mov_b32 v191, -1
    v_mov_b32 v192, -1
    v_mov_b32 v193, -1
    v_mov_b32 v194, -1
    v_mov_b32 v195, -1
    s_lshl_b32 s48, s22, 5
    v_add_u32 v33, s48, v5
    v_min_u32 v33, 252, v33
    v_lshlrev_b32 v33, 3, v33
    s_lshl_b32 s94, s89, 11
    s_add_u32 s94, s94, 8192
    v_lshrrev_b32 v196, 2, v4
    v_and_b32 v197, 1, v3
    v_lshl_or_b32 v198, v197, 2, v196
    v_lshl_add_u32 v196, v3, 3, v196
    v_and_b32 v199, 3, v2
    s_lshl_b32 s48, s22, 1
    v_xor_b32 v84, s48, v198
    v_lshlrev_b32 v84, 5, v84
    v_lshl_add_u32 v84, v196, 9, v84
    v_lshl_add_u32 v84, v199, 3, v84
    v_xor_b32 v85, v3, v4
    v_lshlrev_b32 v85, 4, v85
    v_lshl_add_u32 v85, v4, 8, v85
    v_xor_b32 v86, 64, v85
    v_xor_b32 v87, 128, v85
    v_xor_b32 v88, 192, v85
    s_lshl_b32 s48, s22, 2
    v_lshrrev_b32 v89, 1, v3
    v_add_u32 v89, s48, v89
    v_xor_b32 v89, v89, v4
    v_lshlrev_b32 v89, 4, v89
    v_lshl_add_u32 v89, v4, 9, v89
    v_lshl_add_u32 v89, v197, 3, v89
    v_xor_b32 v90, 32, v89
    v_lshrrev_b32 v196, 5, v0
    v_xor_b32 v91, v196, v5
    v_lshlrev_b32 v91, 4, v91
    v_lshl_add_u32 v91, v196, 9, v91
    s_cmp_eq_u32 s88, 0
    s_cbranch_scc1 L_gemm
    s_add_u32 s36, s20, 5242880
    s_addc_u32 s37, s21, 0
    s_mov_b32 s38, 4096000
    s_mov_b32 s39, 0x00020000
    s_mov_b32 s52, s12
    s_mov_b32 s53, s13
    s_mov_b32 s54, 139264
    s_mov_b32 s55, 0x00020000
    s_mov_b32 s40, 52429
    s_mov_b32 s41, -40
    v_mov_b32 v124, -2
    s_waitcnt lgkmcnt(0)
    s_barrier
    s_waitcnt vmcnt(7)
    v_mul_u32_u24 v125, s40, v108
    v_lshrrev_b32 v125, 21, v125
    v_lshlrev_b32 v130, 2, v125
    ds_add_rtn_u32 v135, v130, v200 offset:30720
    v_mul_u32_u24 v126, s40, v109
    v_lshrrev_b32 v126, 21, v126
    v_lshlrev_b32 v131, 2, v126
    ds_add_rtn_u32 v136, v131, v200 offset:30720
    v_mul_u32_u24 v127, s40, v110
    v_lshrrev_b32 v127, 21, v127
    v_lshlrev_b32 v132, 2, v127
    ds_add_rtn_u32 v137, v132, v200 offset:30720
    v_mul_u32_u24 v128, s40, v111
    v_lshrrev_b32 v128, 21, v128
    v_lshlrev_b32 v133, 2, v128
    ds_add_rtn_u32 v138, v133, v200 offset:30720
    s_waitcnt vmcnt(6)
    v_mul_u32_u24 v129, s40, v112
    v_lshrrev_b32 v129, 21, v129
    v_lshlrev_b32 v134, 2, v129
    ds_add_rtn_u32 v139, v134, v200 offset:30720
    s_add_u32 m0, s47, 97920
    s_add_u32 s44, s47, 0
    buffer_load_dwordx4 v83, s[52:55], s44 offen offset:0 lds
    buffer_load_dwordx4 v252, s[52:55], s44 offen offset:1024 lds
    buffer_load_dwordx4 v83, s[52:55], s44 offen offset:2048 lds
    buffer_load_dwordx4 v252, s[52:55], s44 offen offset:3072 lds
    v_lshrrev_b32 v141, 3, v0
    v_and_b32 v142, 7, v0
    v_lshlrev_b32 v141, 14, v141
    v_lshl_add_u32 v141, v142, 4, v141
    v_add_u32 v142, 2048, v0
    v_mad_i32_i24 v108, v125, s41, v108
    v_lshl_or_b32 v108, v108, 26, v255
    v_mad_i32_i24 v109, v126, s41, v109
    v_lshl_or_b32 v109, v109, 26, v255
    v_or_b32 v109, 1, v109
    v_mad_i32_i24 v110, v127, s41, v110
    v_lshl_or_b32 v110, v110, 26, v255
    v_or_b32 v110, 2, v110
    v_mad_i32_i24 v111, v128, s41, v111
    v_lshl_or_b32 v111, v111, 26, v255
    v_or_b32 v111, 3, v111
    v_mad_i32_i24 v112, v129, s41, v112
    v_lshl_or_b32 v112, v112, 26, v142
    s_waitcnt vmcnt(8) lgkmcnt(0)
    v_cmp_lt_u32 vcc, 28, v135
    v_lshl_or_b32 v114, v114, 12, v108
    v_min_u32 v135, 30, v135
    v_addc_co_u32 v135, vcc, 0, v135, vcc
    v_cmp_eq_u32 vcc, 31, v135
    v_and_b32 v140, 3, v135
    v_and_b32 v135, 28, v135
    v_cndmask_b32 v114, v114, v124, vcc
    v_lshl_add_u32 v135, v140, 5, v135
    v_lshl_add_u32 v135, v125, 7, v135
    ds_write_b32 v135, v114 offset:32384
    v_cmp_lt_u32 vcc, 28, v136
    v_lshl_or_b32 v115, v115, 12, v109
    v_min_u32 v136, 30, v136
    v_addc_co_u32 v136, vcc, 0, v136, vcc
    v_cmp_eq_u32 vcc, 31, v136
    v_and_b32 v140, 3, v136
    v_and_b32 v136, 28, v136
    v_cndmask_b32 v115, v115, v124, vcc
    v_lshl_add_u32 v136, v140, 5, v136
    v_lshl_add_u32 v136, v126, 7, v136
    ds_write_b32 v136, v115 offset:32384
    v_cmp_lt_u32 vcc, 28, v137
    v_lshl_or_b32 v116, v116, 12, v110
    v_min_u32 v137, 30, v137
    v_addc_co_u32 v137, vcc, 0, v137, vcc
    v_cmp_eq_u32 vcc, 31, v137
    v_and_b32 v140, 3, v137
    v_and_b32 v137, 28, v137
    v_cndmask_b32 v116, v116, v124, vcc
    v_lshl_add_u32 v137, v140, 5, v137
    v_lshl_add_u32 v137, v127, 7, v137
    ds_write_b32 v137, v116 offset:32384
    v_cmp_lt_u32 vcc, 28, v138
    v_lshl_or_b32 v117, v117, 12, v111
    v_min_u32 v138, 30, v138
    v_addc_co_u32 v138, vcc, 0, v138, vcc
    v_cmp_eq_u32 vcc, 31, v138
    v_and_b32 v140, 3, v138
    v_and_b32 v138, 28, v138
    v_cndmask_b32 v117, v117, v124, vcc
    v_lshl_add_u32 v138, v140, 5, v138
    v_lshl_add_u32 v138, v128, 7, v138
    ds_write_b32 v138, v117 offset:32384
    v_cmp_lt_u32 vcc, 28, v139
    v_lshl_or_b32 v118, v118, 12, v112
    v_min_u32 v139, 30, v139
    v_addc_co_u32 v139, vcc, 0, v139, vcc
    v_cmp_eq_u32 vcc, 31, v139
    v_and_b32 v140, 3, v139
    v_and_b32 v139, 28, v139
    v_cndmask_b32 v118, v118, v124, vcc
    v_lshl_add_u32 v139, v140, 5, v139
    v_lshl_add_u32 v139, v129, 7, v139
    ds_write_b32 v139, v118 offset:32384
    s_mul_i32 s80, s86, 1664525
    s_add_u32 s80, s80, 1013904223
    s_mul_i32 s81, s87, 22695477
    s_add_u32 s81, s81, 1
    v_and_b32 v142, 3, v0
    v_cmp_eq_u32 vcc, 3, v142
    s_not_b32 s45, s80
    v_mov_b32 v143, s45
    v_cndmask_b32 v143, 0, v143, vcc
    s_add_u32 m0, s47, 102016
    s_add_u32 s44, s47, 4096
    buffer_load_dwordx4 v253, s[52:55], s44 offen offset:0 lds
    buffer_load_dwordx4 v254, s[52:55], s44 offen offset:1024 lds
    buffer_load_dwordx4 v253, s[52:55], s44 offen offset:2048 lds
    buffer_load_dwordx4 v254, s[52:55], s44 offen offset:3072 lds
    s_lshl_b32 s44, s83, 7
    s_waitcnt lgkmcnt(0)
    s_barrier
    ds_read_b128 v[144:147], v119 offset:32384
    ds_read_b128 v[148:151], v119 offset:40576
    ds_read_b128 v[152:155], v119 offset:48768
    ds_read_b128 v[156:159], v119 offset:56960
    s_waitcnt lgkmcnt(3)
    v_xor_b32 v147, v147, v143
    buffer_store_dwordx4 v[144:147], v141, s[36:39], s44 offen sc1
    s_add_u32 s44, s44, 1048576
    s_waitcnt lgkmcnt(2)
    v_xor_b32 v151, v151, v143
    buffer_store_dwordx4 v[148:151], v141, s[36:39], s44 offen sc1
    s_add_u32 s44, s44, 1048576
    s_waitcnt lgkmcnt(1)
    v_xor_b32 v155, v155, v143
    buffer_store_dwordx4 v[152:155], v141, s[36:39], s44 offen sc1
    s_add_u32 s44, s44, 1048576
    s_waitcnt lgkmcnt(0)
    v_xor_b32 v159, v159, v143
    buffer_store_dwordx4 v[156:159], v141, s[36:39], s44 offen sc1
L_gemm:
    s_cmp_eq_u32 s88, 0
    s_cbranch_scc0 L_w4
    s_waitcnt vmcnt(0)
L_w4:
    s_waitcnt vmcnt(4) lgkmcnt(0)
    s_barrier
    ds_read_b128 v[108:111], v85 offset:0
    ds_read_b128 v[112:115], v86 offset:0
    ds_read_b128 v[116:119], v87 offset:0
    ds_read_b128 v[120:123], v88 offset:0
    ds_read_b128 v[124:127], v85 offset:4096
    ds_read_b128 v[128:131], v86 offset:4096
    ds_read_b128 v[132:135], v87 offset:4096
    ds_read_b128 v[136:139], v88 offset:4096
    ds_read_b128 v[140:143], v85 offset:8192
    ds_read_b128 v[144:147], v86 offset:8192
    ds_read_b128 v[148:151], v87 offset:8192
    ds_read_b128 v[152:155], v88 offset:8192
    v_add_u32 v198, 97920, v84
    v_xor_b32 v199, 32, v198
    ds_read_b64_tr_b16 v[210:211], v198 offset:0
    ds_read_b64_tr_b16 v[212:213], v198 offset:2048
    ds_read_b64_tr_b16 v[214:215], v198 offset:16384
    ds_read_b64_tr_b16 v[216:217], v198 offset:18432
    ds_read_b64_tr_b16 v[218:219], v198 offset:32768
    ds_read_b64_tr_b16 v[220:221], v198 offset:34816
    ds_read_b64_tr_b16 v[222:223], v198 offset:49152
    ds_read_b64_tr_b16 v[224:225], v198 offset:51200
    ds_read_b64_tr_b16 v[226:227], v199 offset:0
    ds_read_b64_tr_b16 v[228:229], v199 offset:2048
    ds_read_b64_tr_b16 v[230:231], v199 offset:16384
    ds_read_b64_tr_b16 v[232:233], v199 offset:18432
    ds_read_b64_tr_b16 v[234:235], v199 offset:32768
    ds_read_b64_tr_b16 v[236:237], v199 offset:34816
    ds_read_b64_tr_b16 v[238:239], v199 offset:49152
    ds_read_b64_tr_b16 v[240:241], v199 offset:51200
    s_mul_i32 s80, s86, 1664525
    s_add_u32 s80, s80, 1013904223
    s_mul_i32 s81, s87, 22695477
    s_add_u32 s81, s81, 1
    s_mov_b32 s90, 0xbfb8aa3b
    s_mov_b32 s91, s90
    s_waitcnt lgkmcnt(8)
    v_mfma_f32_16x16x32_bf16 v[160:163], v[210:213], v[108:111], 0
    v_mfma_f32_16x16x32_bf16 v[168:171], v[210:213], v[124:127], 0
    v_mfma_f32_16x16x32_bf16 v[176:179], v[210:213], v[140:143], 0
    s_add_u32 m0, s47, 32384
    s_add_u32 s44, s47, 65536
    buffer_load_dwordx4 v83, s[52:55], s44 offen offset:0 lds
    v_mfma_f32_16x16x32_bf16 v[160:163], v[214:217], v[112:115], v[160:163]
    v_mfma_f32_16x16x32_bf16 v[168:171], v[214:217], v[128:131], v[168:171]
    v_mfma_f32_16x16x32_bf16 v[176:179], v[214:217], v[144:147], v[176:179]
    buffer_load_dwordx4 v252, s[52:55], s44 offen offset:1024 lds
    v_mfma_f32_16x16x32_bf16 v[160:163], v[218:221], v[116:119], v[160:163]
    v_mfma_f32_16x16x32_bf16 v[168:171], v[218:221], v[132:135], v[168:171]
    v_mfma_f32_16x16x32_bf16 v[176:179], v[218:221], v[148:151], v[176:179]
    buffer_load_dwordx4 v83, s[52:55], s44 offen offset:2048 lds
    v_mfma_f32_16x16x32_bf16 v[160:163], v[222:225], v[120:123], v[160:163]
    v_mfma_f32_16x16x32_bf16 v[168:171], v[222:225], v[136:139], v[168:171]
    v_mfma_f32_16x16x32_bf16 v[176:179], v[222:225], v[152:155], v[176:179]
    buffer_load_dwordx4 v252, s[52:55], s44 offen offset:3072 lds
    s_waitcnt lgkmcnt(0)
    v_mfma_f32_16x16x32_bf16 v[164:167], v[226:229], v[108:111], 0
    v_mfma_f32_16x16x32_bf16 v[172:175], v[226:229], v[124:127], 0
    v_mfma_f32_16x16x32_bf16 v[180:183], v[226:229], v[140:143], 0
    s_add_u32 m0, s47, 36480
    s_add_u32 s44, s47, 69632
    buffer_load_dwordx4 v253, s[52:55], s44 offen offset:0 lds
    v_mfma_f32_16x16x32_bf16 v[164:167], v[230:233], v[112:115], v[164:167]
    v_mfma_f32_16x16x32_bf16 v[172:175], v[230:233], v[128:131], v[172:175]
    v_mfma_f32_16x16x32_bf16 v[180:183], v[230:233], v[144:147], v[180:183]
    buffer_load_dwordx4 v254, s[52:55], s44 offen offset:1024 lds
    v_mfma_f32_16x16x32_bf16 v[164:167], v[234:237], v[116:119], v[164:167]
    v_mfma_f32_16x16x32_bf16 v[172:175], v[234:237], v[132:135], v[172:175]
    v_mfma_f32_16x16x32_bf16 v[180:183], v[234:237], v[148:151], v[180:183]
    buffer_load_dwordx4 v253, s[52:55], s44 offen offset:2048 lds
    v_mfma_f32_16x16x32_bf16 v[164:167], v[238:241], v[120:123], v[164:167]
    v_mfma_f32_16x16x32_bf16 v[172:175], v[238:241], v[136:139], v[172:175]
    v_mfma_f32_16x16x32_bf16 v[180:183], v[238:241], v[152:155], v[180:183]
    buffer_load_dwordx4 v254, s[52:55], s44 offen offset:3072 lds
    s_add_u32 s40, s20, 4096
    s_addc_u32 s41, s21, 0
    s_mov_b32 s42, 5120000
    s_mov_b32 s43, 0x00020000
    s_mul_i32 s44, s2, 20480
    v_lshlrev_b32 v196, 4, v0
    v_pk_mul_f32 v[160:161], v[160:161], s[90:91]
    v_pk_mul_f32 v[162:163], v[162:163], s[90:91]
    v_cvt_pk_bf16_f32 v160, v160, v161
    v_cvt_pk_bf16_f32 v161, v162, v163
    ds_write_b64 v89, v[160:161] offset:10240
    v_pk_mul_f32 v[168:169], v[168:169], s[90:91]
    v_pk_mul_f32 v[170:171], v[170:171], s[90:91]
    v_cvt_pk_bf16_f32 v168, v168, v169
    v_cvt_pk_bf16_f32 v169, v170, v171
    ds_write_b64 v89, v[168:169] offset:18432
    v_pk_mul_f32 v[176:177], v[176:177], s[90:91]
    v_pk_mul_f32 v[178:179], v[178:179], s[90:91]
    v_cvt_pk_bf16_f32 v176, v176, v177
    v_cvt_pk_bf16_f32 v177, v178, v179
    v_pk_mul_f32 v[164:165], v[164:165], s[90:91]
    v_pk_mul_f32 v[166:167], v[166:167], s[90:91]
    v_cvt_pk_bf16_f32 v164, v164, v165
    v_cvt_pk_bf16_f32 v165, v166, v167
    ds_write_b64 v90, v[164:165] offset:10240
    v_pk_mul_f32 v[172:173], v[172:173], s[90:91]
    v_pk_mul_f32 v[174:175], v[174:175], s[90:91]
    v_cvt_pk_bf16_f32 v172, v172, v173
    v_cvt_pk_bf16_f32 v173, v174, v175
    ds_write_b64 v90, v[172:173] offset:18432
    v_pk_mul_f32 v[180:181], v[180:181], s[90:91]
    v_pk_mul_f32 v[182:183], v[182:183], s[90:91]
    v_cvt_pk_bf16_f32 v180, v180, v181
    v_cvt_pk_bf16_f32 v181, v182, v183
    s_mov_b32 exec_lo, 0x00ff00ff
    s_mov_b32 exec_hi, 0x00ff00ff
    ds_write_b64 v89, v[176:177] offset:26624
    ds_write_b64 v90, v[180:181] offset:26624
    s_mov_b64 exec, -1
    s_waitcnt lgkmcnt(0)
    s_barrier
    ds_read_b128 v[242:245], v91 offset:10240
    ds_read_b128 v[246:249], v91 offset:18432
    s_cmp_ge_u32 s22, 4
    s_cbranch_scc1 L_g2
    ds_read_b128 v[184:187], v91 offset:26624
    s_add_u32 s45, s44, 16384
    s_waitcnt lgkmcnt(0)
    buffer_store_dwordx4 v[184:187], v196, s[40:43], s45 offen sc1
L_g2:
    s_add_u32 s45, s44, 8192
    s_waitcnt lgkmcnt(0)
    buffer_store_dwordx4 v[242:245], v196, s[40:43], s44 offen sc1
    buffer_store_dwordx4 v[246:249], v196, s[40:43], s45 offen sc1
L_bgemm:
    s_add_u32 s36, s20, 5242880
    s_addc_u32 s37, s21, 0
    s_mov_b32 s38, 4096000
    s_mov_b32 s39, 0x00020000
    s_waitcnt vmcnt(2)
    s_barrier
    v_add_u32 v198, 32384, v84
    v_xor_b32 v199, 32, v198
    ds_read_b64_tr_b16 v[210:211], v198 offset:0
    ds_read_b64_tr_b16 v[212:213], v198 offset:2048
    ds_read_b64_tr_b16 v[214:215], v198 offset:16384
    ds_read_b64_tr_b16 v[216:217], v198 offset:18432
    ds_read_b64_tr_b16 v[218:219], v198 offset:32768
    ds_read_b64_tr_b16 v[220:221], v198 offset:34816
    ds_read_b64_tr_b16 v[222:223], v198 offset:49152
    ds_read_b64_tr_b16 v[224:225], v198 offset:51200
    ds_read_b64_tr_b16 v[226:227], v199 offset:0
    ds_read_b64_tr_b16 v[228:229], v199 offset:2048
    ds_read_b64_tr_b16 v[230:231], v199 offset:16384
    ds_read_b64_tr_b16 v[232:233], v199 offset:18432
    ds_read_b64_tr_b16 v[234:235], v199 offset:32768
    ds_read_b64_tr_b16 v[236:237], v199 offset:34816
    ds_read_b64_tr_b16 v[238:239], v199 offset:49152
    ds_read_b64_tr_b16 v[240:241], v199 offset:51200
    s_waitcnt lgkmcnt(8)
    v_mfma_f32_16x16x32_bf16 v[160:163], v[210:213], v[108:111], 0
    v_mfma_f32_16x16x32_bf16 v[168:171], v[210:213], v[124:127], 0
    v_mfma_f32_16x16x32_bf16 v[176:179], v[210:213], v[140:143], 0
    v_mfma_f32_16x16x32_bf16 v[160:163], v[214:217], v[112:115], v[160:163]
    v_mfma_f32_16x16x32_bf16 v[168:171], v[214:217], v[128:131], v[168:171]
    v_mfma_f32_16x16x32_bf16 v[176:179], v[214:217], v[144:147], v[176:179]
    v_mfma_f32_16x16x32_bf16 v[160:163], v[218:221], v[116:119], v[160:163]
    v_mfma_f32_16x16x32_bf16 v[168:171], v[218:221], v[132:135], v[168:171]
    v_mfma_f32_16x16x32_bf16 v[176:179], v[218:221], v[148:151], v[176:179]
    v_mfma_f32_16x16x32_bf16 v[160:163], v[222:225], v[120:123], v[160:163]
    v_mfma_f32_16x16x32_bf16 v[168:171], v[222:225], v[136:139], v[168:171]
    v_mfma_f32_16x16x32_bf16 v[176:179], v[222:225], v[152:155], v[176:179]
    s_waitcnt lgkmcnt(0)
    s_barrier
    s_mov_b64 exec, s[96:97]
    buffer_load_dwordx4 v[192:195], v79, s[36:39], s95 offen offset:16 sc1
    buffer_load_dwordx4 v[188:191], v79, s[36:39], s95 offen sc1
    s_mov_b64 exec, -1
    s_add_u32 s52, s20, 9437184
    s_addc_u32 s53, s21, 0
    s_mov_b32 s54, 73728
    s_mov_b32 s55, 0x00020000
    s_lshl_b32 s92, s26, 11
    s_add_u32 s92, s92, 65536
    v_mov_b32 v197, 2016
    buffer_load_dwordx2 v[90:91], v197, s[76:79], s94 offen sc1
    v_mfma_f32_16x16x32_bf16 v[164:167], v[226:229], v[108:111], 0
    v_mfma_f32_16x16x32_bf16 v[172:175], v[226:229], v[124:127], 0
    v_mfma_f32_16x16x32_bf16 v[180:183], v[226:229], v[140:143], 0
    v_mfma_f32_16x16x32_bf16 v[164:167], v[230:233], v[112:115], v[164:167]
    v_mfma_f32_16x16x32_bf16 v[172:175], v[230:233], v[128:131], v[172:175]
    v_mfma_f32_16x16x32_bf16 v[180:183], v[230:233], v[144:147], v[180:183]
    v_mfma_f32_16x16x32_bf16 v[164:167], v[234:237], v[116:119], v[164:167]
    v_mfma_f32_16x16x32_bf16 v[172:175], v[234:237], v[132:135], v[172:175]
    v_mfma_f32_16x16x32_bf16 v[180:183], v[234:237], v[148:151], v[180:183]
    v_mfma_f32_16x16x32_bf16 v[164:167], v[238:241], v[120:123], v[164:167]
    v_mfma_f32_16x16x32_bf16 v[172:175], v[238:241], v[136:139], v[172:175]
    v_mfma_f32_16x16x32_bf16 v[180:183], v[238:241], v[152:155], v[180:183]
    v_mov_b32 v108, 0
    v_mov_b32 v109, 0
    v_mov_b32 v110, 0
    v_mov_b32 v111, 0
    v_mov_b32 v112, -1
    v_mov_b32 v113, 0xffff
    v_mov_b32 v114, -1
    v_mov_b32 v115, 0xffff
    v_lshlrev_b32 v82, 4, v0
    v_mov_b32 v84, 34208
    s_cmp_ge_u32 s22, 3
    s_cbranch_scc1 L_nz
    v_min_u32 v85, 3008, v82
    ds_write_b128 v85, v[108:111] offset:32736
L_nz:
    ds_write_b128 v82, v[112:115] offset:0
    v_min_u32 v85, 7152, v82
    ds_write_b128 v85, v[112:115] offset:8192
    v_min_u32 v85, 1916, v255
    ds_write_b32 v85, v84 offset:15360
    s_lshl_b32 s45, s2, 3
    s_add_u32 s45, s45, 8192
    s_waitcnt vmcnt(3) lgkmcnt(0)
    s_barrier
    s_cmp_lg_u32 s22, 0
    s_cbranch_scc1 L_nofa
    v_mov_b32 v76, s80
    v_mov_b32 v77, s81
    v_lshlrev_b32 v78, 11, v2
    s_mov_b64 exec, 0xff
    buffer_store_dwordx2 v[76:77], v78, s[76:79], s45 offen sc1
    s_mov_b64 exec, -1
L_nofa:
    s_mul_i32 s48, s22, 1552
    s_add_u32 s48, s48, 35760
    v_add_u32 v83, s48, v1
    ds_write_b128 v83, v[108:111] offset:0
    ds_write_b128 v83, v[108:111] offset:12416
    ds_write_b128 v83, v[108:111] offset:24832
    ds_write_b128 v83, v[108:111] offset:37248
    ds_write_b128 v83, v[108:111] offset:49664
    s_mov_b32 s42, 0xA0000000
    s_mov_b32 s43, 2044
    s_lshr_b32 s45, s22, 0
    s_lshl_b32 s45, s45, 2
    v_mov_b32 v199, s45
    s_mov_b32 s44, 0xfff
    v_mov_b32 v198, 0x3f800000
    s_or_b32 s45, s80, 1
    s_mov_b32 s46, 0xaaaaaaaa
    s_mov_b32 s47, s46
    s_and_b64 s[46:47], s[46:47], s[96:97]
    s_mov_b32 s93, 20000
    s_waitcnt vmcnt(1)
    s_cmp_eq_u32 s22, 0
    s_cbranch_scc1 L_pr_c
L_pr_l:
    s_waitcnt vmcnt(0)
L_pr_c:
    v_or_b32 v197, 1, v195
    v_cmp_ne_u32 vcc, s45, v197
    s_and_b64 vcc, vcc, s[46:47]
    s_cbranch_vccz L_pr_done
    s_sub_u32 s93, s93, 1
    s_cbranch_scc1 L_pr_to
    s_sleep 12
    s_mov_b64 exec, s[96:97]
    buffer_load_dwordx4 v[192:195], v79, s[36:39], s95 offen offset:16 sc1
    buffer_load_dwordx4 v[188:191], v79, s[36:39], s95 offen sc1
    s_mov_b64 exec, -1
    s_branch L_pr_l
L_pr_to:
    s_mov_b32 s82, 1
    v_mov_b32 v188, -1
    v_mov_b32 v189, -1
    v_mov_b32 v190, -1
    v_mov_b32 v191, -1
    v_mov_b32 v192, -1
    v_mov_b32 v193, -1
    v_mov_b32 v194, -1
    v_mov_b32 v195, -1
L_pr_done:
    v_cmp_ne_u64 vcc, s[80:81], v[90:91]
    s_cbranch_vccnz L_noc
    buffer_load_dwordx4 v[8:11], v1, s[52:55], s92 offen sc1
    buffer_load_dwordx4 v[12:15], v1, s[52:55], s92 offen offset:1024 sc1
L_noc:
    v_cmp_gt_u32 vcc, s42, v194
    s_mov_b64 s[74:75], vcc
    s_cbranch_vccz L_p1a
    v_lshrrev_b32 v216, 21, v194
    v_cmp_gt_u32 s[58:59], s42, v194
    v_and_b32 v216, s43, v216
    v_lshrrev_b32 v217, 21, v195
    v_cmp_gt_u32 s[60:61], s42, v195
    v_and_b32 v217, s43, v217
    s_andn2_b64 s[60:61], s[60:61], s[46:47]
    s_mov_b64 exec, s[58:59]
    ds_add_rtn_u32 v224, v216, v200 offset:32736
    s_mov_b64 exec, s[60:61]
    ds_add_rtn_u32 v225, v217, v200 offset:32736
    s_mov_b64 exec, -1
    v_cmp_ne_u32 vcc, s80, v195
    s_and_b64 vcc, vcc, s[46:47]
    s_cbranch_vccz L_p1a
    v_mov_b32 v196, 0
    ds_write_b32 v196, v200 offset:34176
L_p1a:
    v_lshrrev_b32 v210, 21, v188
    v_cmp_gt_u32 s[58:59], s42, v188
    v_and_b32 v210, s43, v210
    v_lshrrev_b32 v211, 21, v189
    v_cmp_gt_u32 s[60:61], s42, v189
    v_and_b32 v211, s43, v211
    v_lshrrev_b32 v212, 21, v190
    v_cmp_gt_u32 s[62:63], s42, v190
    v_and_b32 v212, s43, v212
    v_lshrrev_b32 v213, 21, v191
    v_cmp_gt_u32 s[64:65], s42, v191
    v_and_b32 v213, s43, v213
    v_lshrrev_b32 v214, 21, v192
    v_cmp_gt_u32 s[66:67], s42, v192
    v_and_b32 v214, s43, v214
    v_lshrrev_b32 v215, 21, v193
    v_cmp_gt_u32 s[68:69], s42, v193
    v_and_b32 v215, s43, v215
    s_mov_b64 exec, s[58:59]
    ds_add_rtn_u32 v218, v210, v200 offset:32736
    s_mov_b64 exec, s[60:61]
    ds_add_rtn_u32 v219, v211, v200 offset:32736
    s_mov_b64 exec, s[62:63]
    ds_add_rtn_u32 v220, v212, v200 offset:32736
    s_mov_b64 exec, s[64:65]
    ds_add_rtn_u32 v221, v213, v200 offset:32736
    s_mov_b64 exec, s[66:67]
    ds_add_rtn_u32 v222, v214, v200 offset:32736
    s_mov_b64 exec, s[68:69]
    ds_add_rtn_u32 v223, v215, v200 offset:32736
    s_mov_b64 exec, -1
    v_and_b32 v124, s44, v188
    v_bfe_u32 v125, v188, 12, 14
    v_add_u32 v124, v124, v7
    v_or_b32 v125, v198, v125
    v_and_b32 v126, s44, v189
    v_bfe_u32 v127, v189, 12, 14
    v_add_u32 v126, v126, v7
    v_or_b32 v127, v198, v127
    v_and_b32 v128, s44, v190
    v_bfe_u32 v129, v190, 12, 14
    v_add_u32 v128, v128, v7
    v_or_b32 v129, v198, v129
    v_and_b32 v130, s44, v191
    v_bfe_u32 v131, v191, 12, 14
    v_add_u32 v130, v130, v7
    v_or_b32 v131, v198, v131
    v_and_b32 v132, s44, v192
    v_bfe_u32 v133, v192, 12, 14
    v_add_u32 v132, v132, v7
    v_or_b32 v133, v198, v133
    v_and_b32 v134, s44, v193
    v_bfe_u32 v135, v193, 12, 14
    v_add_u32 v134, v134, v7
    v_or_b32 v135, v198, v135
    s_waitcnt lgkmcnt(0)
    s_barrier
    v_mov_b32 v196, 0
    ds_read_b128 v[148:151], v201 offset:32736
    ds_read_b128 v[152:155], v201 offset:32752
    ds_read_b32 v156, v196 offset:34176
    v_and_b32 v197, 1, v3
    v_cmp_eq_u32 s[56:57], 1, v197
    v_mul_u32_u24 v197, 7680, v197
    s_waitcnt lgkmcnt(0)
    v_add_u32 v149, v148, v149
    v_add_u32 v150, v149, v150
    v_add_u32 v151, v150, v151
    v_add_u32 v152, v151, v152
    v_add_u32 v153, v152, v153
    v_add_u32 v154, v153, v154
    v_add_u32 v232, v154, v155
    v_add_u32 v233, 7, v232
    v_lshrrev_b32 v233, 3, v233
    v_cmp_lt_u32 s[40:41], 16, v233
    v_min_u32 v233, 16, v233
    v_lshlrev_b32 v234, 3, v233
    s_mov_b32 exec_hi, 0xff
    ds_or_b64 v234, v[202:203] offset:34016
    s_mov_b32 exec_hi, -1
    ds_read_b64 v[244:245], v205 offset:34024
    ds_read_b64 v[242:243], v234 offset:34016
    buffer_load_dwordx2 v[74:75], v33, s[76:79], s94 offen sc1
    v_sub_u32 v246, v234, v232
    v_and_b32 v246, 7, v246
    v_lshrrev_b32 v246, 0, v246
    v_add_u32 v241, v232, v246
    v_readfirstlane_b32 s72, v156
    v_lshrrev_b32 v234, 1, v234
    s_waitcnt lgkmcnt(1)
    v_bcnt_u32_b32 v235, v244, 0
    v_bcnt_u32_b32 v235, v245, v235
    s_nop 1
    v_add_u32_dpp v235, v235, v235 row_shl:1 row_mask:0xf bank_mask:0xf bound_ctrl:0
    s_nop 1
    v_add_u32_dpp v235, v235, v235 row_shl:2 row_mask:0xf bank_mask:0xf bound_ctrl:0
    s_nop 1
    v_add_u32_dpp v235, v235, v235 row_shl:4 row_mask:0xf bank_mask:0xf bound_ctrl:0
    s_nop 1
    v_add_u32_dpp v235, v235, v235 row_shl:8 row_mask:0xf bank_mask:0xf bound_ctrl:0
    ds_bpermute_b32 v240, v234, v235
    v_subrev_u32 v236, 4, v235
    v_subrev_u32 v199, 20, v235
    v_ashrrev_i32 v236, 1, v236
    v_max3_i32 v236, v236, v199, 0
    v_sub_u32 v199, v235, v236
    v_cndmask_b32 v236, v199, v236, s[56:57]
    v_cmp_lt_u32 vcc, 0, v236
    v_max_u32 v237, 4, v236
    s_nop 0
    v_cndmask_b32 v237, 0, v237, vcc
    v_mov_b32 v238, v237
    s_nop 1
    v_add_u32_dpp v238, v238, v238 row_shr:1 row_mask:0xf bank_mask:0xf bound_ctrl:0
    s_nop 1
    v_add_u32_dpp v238, v238, v238 row_shr:2 row_mask:0xf bank_mask:0xf bound_ctrl:0
    s_nop 1
    v_add_u32_dpp v238, v238, v238 row_shr:4 row_mask:0xf bank_mask:0xf bound_ctrl:0
    s_nop 1
    v_add_u32_dpp v238, v238, v238 row_shr:8 row_mask:0xf bank_mask:0xf bound_ctrl:0
    v_sub_u32 v238, v238, v237
    v_add_u32 v239, v238, v236
    v_lshl_add_u32 v197, v238, 6, v197
    v_lshlrev_b32 v196, 3, v5
    ds_write_b32 v196, v197 offset:32480
    s_and_b32 s48, vcc_lo, 0xffff
    s_bcnt1_i32_b32 s48, s48
    s_sub_u32 s48, s48, 1
    s_max_i32 s48, s48, 0
    s_lshr_b32 s49, vcc_lo, 16
    s_bcnt1_i32_b32 s49, s49
    s_add_u32 s49, s49, 15
    s_max_u32 s49, s49, 16
    s_waitcnt lgkmcnt(1)
    v_cndmask_b32 v239, 0, v239, vcc
    v_mbcnt_lo_u32_b32 v196, v242, 0
    v_mbcnt_hi_u32_b32 v196, v243, v196
    v_cmp_eq_u32 vcc, 16, v233
    v_readlane_b32 s70, v239, s48
    v_readlane_b32 s71, v239, s49
    v_cndmask_b32_e64 v240, v240, 0, vcc
    v_add_u32 v240, v240, v196
    v_mov_b32 v197, 112
    v_subrev_u32 v237, 4, v240
    v_subrev_u32 v199, 20, v240
    v_ashrrev_i32 v237, 1, v237
    v_max3_i32 v237, v237, v199, 0
    v_subrev_u32 v196, 3, v240
    v_subrev_u32 v199, 19, v240
    v_ashrrev_i32 v196, 1, v196
    v_max3_i32 v196, v196, v199, 0
    v_sub_u32 v196, v196, v237
    v_sub_u32 v240, v240, v237
    v_cmp_eq_u32 vcc, 1, v196
    v_lshlrev_b32 v140, 7, v196
    s_nop 0
    v_cndmask_b32 v240, v240, v237, vcc
    v_lshl_or_b32 v140, v240, 8, v140
    v_add_u32 v140, v140, v246
    v_add_u32 v141, v140, v148
    v_add_u32 v142, v140, v149
    v_add_u32 v143, v140, v150
    v_add_u32 v144, v140, v151
    v_add_u32 v145, v140, v152
    v_add_u32 v146, v140, v153
    v_add_u32 v147, v140, v154
    s_mov_b32 exec_hi, 0xff
    ds_write_b128 v201, v[140:143] offset:31200
    ds_write_b128 v201, v[144:147] offset:31216
    s_mov_b32 exec_hi, -1
    ds_read_b32 v108, v210 offset:31200
    ds_read_b32 v109, v211 offset:31200
    ds_read_b32 v110, v212 offset:31200
    ds_read_b32 v111, v213 offset:31200
    ds_read_b32 v112, v214 offset:31200
    ds_read_b32 v113, v215 offset:31200
    v_cmp_lt_u32 vcc, v197, v239
    s_lshl_b32 s48, s22, 2
    v_lshl_add_u32 v197, v196, 6, s48
    ds_bpermute_b32 v242, v197, v238
    ds_bpermute_b32 v243, v197, v238 offset:32
    s_or_b64 s[40:41], s[40:41], vcc
    s_cselect_b32 s48, 1, 0
    s_or_b32 s73, s73, s48
    s_or_b32 s73, s73, s72
    s_cbranch_scc1 L_p3done
    s_add_u32 s49, s22, 8
    v_lshl_add_u32 v197, v196, 5, v240
    v_lshlrev_b32 v197, 2, v197
    v_lshlrev_b32 v199, 2, v2
    v_mul_u32_u24 v196, 960, v196
    v_add_u32 v196, 15360, v196
    s_waitcnt lgkmcnt(2)
    v_add_u32 v218, v218, v108
    v_and_b32 v210, 0xf8, v218
    ds_read_b32 v108, v210 offset:32480
    v_add_u32 v219, v219, v109
    v_and_b32 v211, 0xf8, v219
    ds_read_b32 v109, v211 offset:32480
    v_add_u32 v220, v220, v110
    v_and_b32 v212, 0xf8, v220
    ds_read_b32 v110, v212 offset:32480
    v_add_u32 v221, v221, v111
    v_and_b32 v213, 0xf8, v221
    ds_read_b32 v111, v213 offset:32480
    v_add_u32 v222, v222, v112
    v_and_b32 v214, 0xf8, v222
    ds_read_b32 v112, v214 offset:32480
    v_add_u32 v223, v223, v113
    v_and_b32 v215, 0xf8, v223
    ds_read_b32 v113, v215 offset:32480
    v_bfe_u32 v210, v218, 5, 8
    v_bfi_b32 v218, 7, v218, v210
    v_bfe_u32 v211, v219, 5, 8
    v_bfi_b32 v219, 7, v219, v211
    v_bfe_u32 v212, v220, 5, 8
    v_bfi_b32 v220, 7, v220, v212
    v_bfe_u32 v213, v221, 5, 8
    v_bfi_b32 v221, 7, v221, v213
    v_bfe_u32 v214, v222, 5, 8
    v_bfi_b32 v222, 7, v222, v214
    v_bfe_u32 v215, v223, 5, 8
    v_bfi_b32 v223, 7, v223, v215
    s_mov_b32 exec_hi, 0xff
    ds_write_b32 v197, v204 offset:17280
    ds_write_b32 v199, v232 offset:17536
    s_mov_b32 exec_hi, -1
    s_waitcnt lgkmcnt(8)
    v_add_u32 v242, v242, v240
    v_lshrrev_b32 v197, 2, v242
    v_and_b32 v242, 3, v242
    v_lshl_add_u32 v197, v197, 5, v196
    v_lshl_add_u32 v242, v242, 2, v197
    v_cmp_lt_u32 s[56:57], s22, v233
    v_add_u32 v243, v243, v240
    v_lshrrev_b32 v197, 2, v243
    v_and_b32 v243, 3, v243
    v_lshl_add_u32 v197, v197, 5, v196
    v_lshl_add_u32 v243, v243, 2, v197
    v_cmp_lt_u32 s[40:41], s49, v233
    s_waitcnt lgkmcnt(2)
    v_lshl_add_u32 v218, v218, 3, v108
    v_lshl_add_u32 v219, v219, 3, v109
    v_lshl_add_u32 v220, v220, 3, v110
    v_lshl_add_u32 v221, v221, 3, v111
    v_lshl_add_u32 v222, v222, 3, v112
    v_lshl_add_u32 v223, v223, 3, v113
    s_mov_b64 exec, s[58:59]
    ds_write_b64 v218, v[124:125] offset:0
    s_mov_b64 exec, s[60:61]
    ds_write_b64 v219, v[126:127] offset:0
    s_mov_b64 exec, s[62:63]
    ds_write_b64 v220, v[128:129] offset:0
    s_mov_b64 exec, s[64:65]
    ds_write_b64 v221, v[130:131] offset:0
    s_mov_b64 exec, s[66:67]
    ds_write_b64 v222, v[132:133] offset:0
    s_mov_b64 exec, s[68:69]
    ds_write_b64 v223, v[134:135] offset:0
    s_mov_b64 exec, -1
    s_mov_b32 exec_lo, s56
    s_and_b32 exec_hi, s57, 0xff
    ds_write2_b32 v242, v204, v204 offset0:0 offset1:4
    s_mov_b32 exec_lo, s40
    s_and_b32 exec_hi, s41, 0xff
    ds_write2_b32 v243, v204, v204 offset0:0 offset1:4
    s_mov_b64 exec, -1
    s_cmp_eq_u64 s[74:75], 0
    s_cbranch_scc1 L_p3done
    v_cmp_gt_u32 s[58:59], s42, v194
    v_cmp_gt_u32 s[60:61], s42, v195
    s_andn2_b64 s[60:61], s[60:61], s[46:47]
    v_and_b32 v136, s44, v194
    v_bfe_u32 v137, v194, 12, 14
    v_add_u32 v136, v136, v7
    v_or_b32 v137, v198, v137
    v_and_b32 v138, s44, v195
    v_bfe_u32 v139, v195, 12, 14
    v_add_u32 v138, v138, v7
    v_or_b32 v139, v198, v139
    ds_read_b32 v114, v216 offset:31200
    ds_read_b32 v115, v217 offset:31200
    s_waitcnt lgkmcnt(0)
    v_add_u32 v224, v224, v114
    v_and_b32 v216, 0xf8, v224
    ds_read_b32 v114, v216 offset:32480
    v_add_u32 v225, v225, v115
    v_and_b32 v217, 0xf8, v225
    ds_read_b32 v115, v217 offset:32480
    v_bfe_u32 v216, v224, 5, 8
    v_bfi_b32 v224, 7, v224, v216
    v_bfe_u32 v217, v225, 5, 8
    v_bfi_b32 v225, 7, v225, v217
    s_waitcnt lgkmcnt(0)
    v_lshl_add_u32 v224, v224, 3, v114
    v_lshl_add_u32 v225, v225, 3, v115
    s_mov_b64 exec, s[58:59]
    ds_write_b64 v224, v[136:137] offset:0
    s_mov_b64 exec, s[60:61]
    ds_write_b64 v225, v[138:139] offset:0
    s_mov_b64 exec, -1
L_p3done:
    s_waitcnt lgkmcnt(0)
    s_barrier
    ds_read_b32 v66, v80
    ds_read_b32 v46, v80 offset:1024
    s_mov_b32 m0, s23
    s_waitcnt lgkmcnt(0)
    buffer_load_dwordx4 v[66:67], s[32:35], 0 idxen offen  lds
    v_mul_u32_u24 v196, 1552, v4
    v_lshl_add_u32 v196, v3, 3, v196
    s_lshl_b32 s45, s22, 6
    s_add_u32 s45, s45, 36784
    v_add_u32 v196, s45, v196
    v_lshlrev_b32 v242, 16, v206
    v_and_b32 v243, 0xffff0000, v206
    v_lshlrev_b32 v244, 16, v207
    v_and_b32 v245, 0xffff0000, v207
    v_lshlrev_b32 v246, 16, v208
    v_and_b32 v247, 0xffff0000, v208
    v_lshlrev_b32 v248, 16, v209
    v_and_b32 v249, 0xffff0000, v209
    v_pk_mul_f32 v[242:243], v[242:243], s[90:91]
    v_pk_mul_f32 v[244:245], v[244:245], s[90:91]
    v_pk_mul_f32 v[246:247], v[246:247], s[90:91]
    v_pk_mul_f32 v[248:249], v[248:249], s[90:91]
    v_pk_fma_f32 v[160:161], v[160:161], s[90:91], v[242:243]
    v_pk_fma_f32 v[162:163], v[162:163], s[90:91], v[244:245]
    v_cvt_pk_bf16_f32 v160, v160, v161
    v_cvt_pk_bf16_f32 v161, v162, v163
    ds_write_b64 v196, v[160:161] offset:0
    v_pk_fma_f32 v[164:165], v[164:165], s[90:91], v[246:247]
    v_pk_fma_f32 v[166:167], v[166:167], s[90:91], v[248:249]
    v_cvt_pk_bf16_f32 v164, v164, v165
    v_cvt_pk_bf16_f32 v165, v166, v167
    ds_write_b64 v196, v[164:165] offset:32
    v_pk_fma_f32 v[168:169], v[168:169], s[90:91], v[242:243]
    v_pk_fma_f32 v[170:171], v[170:171], s[90:91], v[244:245]
    v_cvt_pk_bf16_f32 v168, v168, v169
    v_cvt_pk_bf16_f32 v169, v170, v171
    ds_write_b64 v196, v[168:169] offset:24832
    v_pk_fma_f32 v[172:173], v[172:173], s[90:91], v[246:247]
    v_pk_fma_f32 v[174:175], v[174:175], s[90:91], v[248:249]
    v_cvt_pk_bf16_f32 v172, v172, v173
    v_cvt_pk_bf16_f32 v173, v174, v175
    ds_write_b64 v196, v[172:173] offset:24864
    s_mov_b32 exec_lo, 0x00ff00ff
    s_mov_b32 exec_hi, 0x00ff00ff
    v_pk_fma_f32 v[176:177], v[176:177], s[90:91], v[242:243]
    v_pk_fma_f32 v[178:179], v[178:179], s[90:91], v[244:245]
    v_cvt_pk_bf16_f32 v176, v176, v177
    v_cvt_pk_bf16_f32 v177, v178, v179
    ds_write_b64 v196, v[176:177] offset:49664
    v_pk_fma_f32 v[180:181], v[180:181], s[90:91], v[246:247]
    v_pk_fma_f32 v[182:183], v[182:183], s[90:91], v[248:249]
    v_cvt_pk_bf16_f32 v180, v180, v181
    v_cvt_pk_bf16_f32 v181, v182, v183
    ds_write_b64 v196, v[180:181] offset:49696
    s_mov_b64 exec, -1
    s_add_u32 s52, s20, 9437184
    s_addc_u32 s53, s21, 0
    s_mov_b32 s54, 73728
    s_mov_b32 s55, 0x00020000
    s_lshl_b32 s48, s22, 13
    s_add_u32 s49, s48, 4096
    s_lshl_b32 s47, s26, 11
    s_add_u32 s47, s47, 65536
    s_cmp_eq_u32 s27, 0
    s_cselect_b32 s70, s70, s71
    s_add_u32 s70, s70, 3
    s_lshr_b32 s70, s70, 2
    s_sub_u32 s72, s70, 5
    s_andn2_b32 s72, s72, 3
    s_add_u32 s72, s72, 1
    s_mov_b32 s71, 0
    v_mov_b32 v196, 0
    s_cmp_lg_u32 s82, 0
    s_cbranch_scc1 L_pa_to
    s_waitcnt vmcnt(1)
    s_mov_b32 s93, 20000
L_pa_l:
    v_cmp_ne_u64 vcc, s[80:81], v[74:75]
    s_cbranch_vccz L_pa_ok
    s_sub_u32 s93, s93, 1
    s_cbranch_scc1 L_pa_to
    s_sleep 6
    buffer_load_dwordx2 v[74:75], v33, s[76:79], s94 offen sc1
    s_waitcnt vmcnt(0)
    s_branch L_pa_l
L_pa_to:
    ds_write_b32 v196, v200 offset:34184
L_pa_ok:
    s_waitcnt lgkmcnt(0)
    s_barrier
    ds_read_b32 v197, v196 offset:34184
    ds_read_u16 v92, v34 offset:4
    ds_read_u16 v94, v34 offset:68
    ds_read_u16 v96, v34 offset:132
    ds_read_u16 v98, v34 offset:196
    ds_read_u16 v100, v34 offset:260
    ds_read_u16 v102, v34 offset:324
    ds_read_u16 v104, v34 offset:388
    ds_read_u16 v106, v34 offset:452
    ds_read_u16 v26, v35 offset:6
    ds_read_b32 v32, v36 offset:0
    ds_read_b64 v[44:45], v37 offset:0
    s_mov_b32 m0, s51
    s_waitcnt lgkmcnt(7)
    v_readfirstlane_b32 s82, v197
    s_nop 3
    s_or_b32 s73, s73, s82
    s_cbranch_scc1 L_slow
    v_cmp_ne_u64 vcc, s[80:81], v[90:91]
    s_cbranch_vccz L_havec
    buffer_load_dwordx4 v[8:11], v1, s[52:55], s47 offen sc1
    buffer_load_dwordx4 v[12:15], v1, s[52:55], s47 offen offset:1024 sc1
L_havec:
    buffer_load_dwordx4 v[92:93], s[28:31], 0 idxen offen offset:0 sc1 lds
    buffer_load_dwordx4 v[94:95], s[28:31], 0 idxen offen offset:1024 sc1 lds
    buffer_load_dwordx4 v[96:97], s[28:31], 0 idxen offen offset:2048 sc1 lds
    buffer_load_dwordx4 v[98:99], s[28:31], 0 idxen offen offset:3072 sc1 lds
    s_waitcnt lgkmcnt(0)
    s_mov_b32 m0, s50
    s_nop 0
    buffer_load_dwordx4 v[100:101], s[28:31], 0 idxen offen offset:0 sc1 lds
    buffer_load_dwordx4 v[102:103], s[28:31], 0 idxen offen offset:1024 sc1 lds
    buffer_load_dwordx4 v[104:105], s[28:31], 0 idxen offen offset:2048 sc1 lds
    buffer_load_dwordx4 v[106:107], s[28:31], 0 idxen offen offset:3072 sc1 lds
    v_lshlrev_b32 v24, v28, v26
    v_lshlrev_b32 v87, v28, v26
    v_add_u32_e64 v30, v32, v31
    v_lshl_add_u64 v[62:63], v[44:45], 0, v[42:43]
    v_mov_b32 v86, 0
    v_mov_b32 v74, 0
    v_mov_b32 v75, 0
    v_mov_b32 v66, 0
    v_mov_b32 v67, 0
    v_mov_b32 v82, 4096
    s_mov_b32 s89, 4096
    s_mov_b32 s88, 4
    s_lshl_b32 s45, s27, 2
    v_mov_b32 v83, s45
    v_mov_b32 v85, v79
    v_mov_b32 v210, -1
    v_mov_b32 v211, -1
    v_mov_b32 v212, -1
    v_mov_b32 v213, -1
    v_mov_b32 v214, -1
    v_mov_b32 v215, -1
    v_mov_b32 v216, -1
    v_mov_b32 v217, -1
    v_mov_b32 v227, v49
    v_mov_b32 v229, v51
    v_mov_b32 v231, v53
    v_mov_b32 v233, v55
    ds_read_b64_tr_b16 v[60:61], v30 offset:0
    ds_read_u16 v48, v34 offset:516
    ds_read_u16 v50, v34 offset:580
    ds_read_u16 v52, v34 offset:644
    ds_read_u16 v54, v34 offset:708
    ds_read_u16 v226, v34 offset:772
    ds_read_u16 v228, v34 offset:836
    ds_read_u16 v230, v34 offset:900
    ds_read_u16 v232, v34 offset:964
    ds_read_b32 v32, v36 offset:32
    ds_read_u16 v26, v35 offset:262
    ds_read_b64 v[44:45], v37 offset:32
    s_lshl_b32 s45, s27, 7
    v_lshl_add_u32 v198, v3, 2, s45
    v_lshlrev_b32 v199, 2, v4
    ds_read_b32 v218, v198 offset:17280
    ds_read_b32 v219, v198 offset:17296
    ds_read_b32 v220, v198 offset:17312
    ds_read_b32 v221, v198 offset:17328
    ds_read_b32 v222, v198 offset:17344
    ds_read_b32 v223, v199 offset:17536
    ds_read_b32 v224, v199 offset:17600
    ds_read_b32 v225, v199 offset:17664
    v_lshlrev_b32 v246, 16, v70
    v_and_b32 v247, 0xffff0000, v70
    v_lshlrev_b32 v248, 16, v71
    v_and_b32 v249, 0xffff0000, v71
    s_lshl_b32 s45, s26, 8
    v_lshl_add_u32 v198, v4, 4, s45
    v_lshrrev_b32 v199, 1, v198
    s_mov_b32 s45, 0xbfb8aa3b
    s_waitcnt lgkmcnt(0)
    v_add_u32 v201, v218, v198
    v_add_u32 v218, v218, v199
    v_add_u32 v202, v219, v198
    v_add_u32 v219, v219, v199
    v_add_u32 v203, v220, v198
    v_add_u32 v220, v220, v199
    v_add_u32 v204, v221, v198
    v_add_u32 v221, v221, v199
    v_add_u32 v205, v222, v198
    v_add_u32 v222, v222, v199
    v_cvt_f32_u32 v223, v223
    v_mul_f32 v223, s45, v223
    v_cvt_f32_u32 v224, v224
    v_mul_f32 v224, s45, v224
    v_cvt_f32_u32 v225, v225
    v_mul_f32 v225, s45, v225
    v_mul_f32 v234, v223, v246
    v_mul_f32 v235, v223, v247
    v_mul_f32 v236, v223, v248
    v_mul_f32 v237, v223, v249
    v_mul_f32 v238, v224, v246
    v_mul_f32 v239, v224, v247
    v_mul_f32 v240, v224, v248
    v_mul_f32 v241, v224, v249
    v_mul_f32 v242, v225, v246
    v_mul_f32 v243, v225, v247
    v_mul_f32 v244, v225, v248
    v_mul_f32 v245, v225, v249
    s_waitcnt vmcnt(8)
    s_mov_b64 exec, 1
    ds_add_u32 v83, v200 offset:34200
    s_mov_b64 exec, -1
    s_waitcnt vmcnt(4)
L_g_l:
    ds_read_b32 v84, v83 offset:34200
    s_waitcnt lgkmcnt(0)
    v_cmp_gt_u32 vcc, 4, v84
    s_cbranch_vccnz L_g_l
    s_cmp_eq_u32 s70, 0
    s_cbranch_scc1 L_mdone
    ds_read_b128 v[76:79], v81 offset:0
    ds_read_b128 v[92:95], v56 offset:0
    ds_read_b128 v[96:99], v57 offset:0
    ds_read_b128 v[100:103], v58 offset:0
    ds_read_b128 v[104:107], v59 offset:0
    s_mov_b32 m0, s51
    s_waitcnt lgkmcnt(0)
    v_mfma_f32_32x32x16_bf16 v[124:139], v[76:79], v[8:11], 0
    v_mfma_f32_32x32x16_bf16 v[124:139], v[92:95], v[16:19], v[124:139]
    v_mfma_f32_32x32x16_bf16 v[124:139], v[96:99], v[20:23], v[124:139]
    v_mfma_f32_32x32x8_bf16 v[124:139], v[24:25], v[60:61], v[124:139]
    v_mfma_f32_32x32x16_bf16 v[140:155], v[76:79], v[12:15], 0
    v_mfma_f32_32x32x16_bf16 v[140:155], v[100:103], v[16:19], v[140:155]
    v_mfma_f32_32x32x16_bf16 v[140:155], v[104:107], v[20:23], v[140:155]
    v_mfma_f32_32x32x8_bf16 v[140:155], v[86:87], v[60:61], v[140:155]
    v_add_u32_e64 v30, v32, v31
    s_nop 6
    v_exp_f32 v108, v124
    v_exp_f32 v109, v125
    v_exp_f32 v110, v126
    v_exp_f32 v111, v127
    v_exp_f32 v112, v128
    v_exp_f32 v113, v129
    v_exp_f32 v114, v130
    v_exp_f32 v115, v131
    v_exp_f32 v116, v132
    buffer_load_dwordx4 v[48:49], s[28:31], 0 idxen offen offset:0 sc1 lds
    buffer_load_dwordx4 v[50:51], s[28:31], 0 idxen offen offset:1024 sc1 lds
    buffer_load_dwordx4 v[52:53], s[28:31], 0 idxen offen offset:2048 sc1 lds
    buffer_load_dwordx4 v[54:55], s[28:31], 0 idxen offen offset:3072 sc1 lds
    ds_read_u16 v48, v34 offset:1028
    ds_read_u16 v50, v34 offset:1092
    ds_read_u16 v52, v34 offset:1156
    ds_read_u16 v54, v34 offset:1220
    ds_read_b32 v32, v36 offset:64
    s_waitcnt vmcnt(4)
    ds_read_b128 v[92:95], v56 offset:4096
    ds_read_b128 v[96:99], v57 offset:4096
    ds_read_b128 v[100:103], v58 offset:4096
    ds_read_b128 v[104:107], v59 offset:4096
    ds_read_b128 v[76:79], v81 offset:256
    ds_read_b64_tr_b16 v[60:61], v30 offset:0
    s_waitcnt lgkmcnt(0)
    s_add_u32 m0, s23, 4096
    s_nop 0
    buffer_load_dwordx4 v[46:47], s[32:35], 0 idxen offen  lds
    s_mov_b32 m0, s50
    s_nop 0
    buffer_load_dwordx4 v[226:227], s[28:31], 0 idxen offen offset:0 sc1 lds
    buffer_load_dwordx4 v[228:229], s[28:31], 0 idxen offen offset:1024 sc1 lds
    buffer_load_dwordx4 v[230:231], s[28:31], 0 idxen offen offset:2048 sc1 lds
    buffer_load_dwordx4 v[232:233], s[28:31], 0 idxen offen offset:3072 sc1 lds
L_loop:
    .p2align 3
    v_exp_f32 v117, v133
    v_exp_f32 v118, v134
    v_exp_f32 v119, v135
    v_exp_f32 v120, v136
    v_exp_f32 v121, v137
    v_exp_f32 v122, v138
    v_exp_f32 v123, v139
    s_setprio 1
    v_pk_add_f32 v[68:69], v[108:109], 1.0 op_sel_hi:[1,0]
    v_lshlrev_b32 v24, v28, v26
    v_lshlrev_b32 v87, v28, v26
    v_lshl_add_u64 v[64:65], v[44:45], 0, v[42:43]
    v_add_u32_e64 v30, v32, v31
    v_pk_fma_f32 v[70:71], v[124:125], v[110:111], v[124:125]
    v_pk_fma_f32 v[66:67], v[126:127], v[68:69], v[70:71]
    v_pk_fma_f32 v[68:69], v[68:69], v[110:111], v[68:69]
    v_pk_fma_f32 v[70:71], v[66:67], v[112:113], v[66:67]
    v_pk_fma_f32 v[66:67], v[128:129], v[68:69], v[70:71]
    v_pk_fma_f32 v[68:69], v[68:69], v[112:113], v[68:69]
    v_pk_fma_f32 v[70:71], v[66:67], v[114:115], v[66:67]
    v_pk_fma_f32 v[66:67], v[130:131], v[68:69], v[70:71]
    v_pk_fma_f32 v[68:69], v[68:69], v[114:115], v[68:69]
    v_pk_fma_f32 v[70:71], v[66:67], v[116:117], v[66:67]
    v_pk_fma_f32 v[66:67], v[132:133], v[68:69], v[70:71]
    v_pk_fma_f32 v[68:69], v[68:69], v[116:117], v[68:69]
    v_pk_fma_f32 v[70:71], v[66:67], v[118:119], v[66:67]
    v_pk_fma_f32 v[66:67], v[134:135], v[68:69], v[70:71]
    v_pk_fma_f32 v[68:69], v[68:69], v[118:119], v[68:69]
    v_pk_fma_f32 v[70:71], v[66:67], v[120:121], v[66:67]
    v_pk_fma_f32 v[66:67], v[136:137], v[68:69], v[70:71]
    v_pk_fma_f32 v[68:69], v[68:69], v[120:121], v[68:69]
    v_pk_fma_f32 v[70:71], v[66:67], v[122:123], v[66:67]
    v_pk_fma_f32 v[66:67], v[138:139], v[68:69], v[70:71]
    v_pk_fma_f32 v[68:69], v[68:69], v[122:123], v[68:69]
    v_max3_f32 v29, v29, v68, v69
    v_mfma_f32_32x32x16_bf16 v[124:139], v[76:79], v[8:11], 0
    v_rcp_f32 v68, v68
    v_rcp_f32 v69, v69
    v_exp_f32_e64 v108, v140
    v_mfma_f32_32x32x16_bf16 v[124:139], v[92:95], v[16:19], v[124:139]
    v_exp_f32 v109, v141
    v_exp_f32 v110, v142
    v_exp_f32_e64 v111, v143
    v_mfma_f32_32x32x16_bf16 v[124:139], v[96:99], v[20:23], v[124:139]
    v_exp_f32 v112, v144
    v_exp_f32 v113, v145
    v_exp_f32_e64 v114, v146
    v_mfma_f32_32x32x8_bf16 v[124:139], v[24:25], v[60:61], v[124:139]
    v_exp_f32 v115, v147
    v_exp_f32 v116, v148
    v_exp_f32 v117, v149
    v_exp_f32 v118, v150
    v_exp_f32 v119, v151
    v_exp_f32 v120, v152
    v_exp_f32 v121, v153
    v_exp_f32 v122, v154
    v_exp_f32_e64 v123, v155
    v_fmac_f32 v72, v66, v68
    v_fmac_f32 v74, v67, v69
    v_pk_add_f32 v[68:69], v[108:109], 1.0 op_sel_hi:[1,0]
    v_pk_fma_f32 v[70:71], v[140:141], v[110:111], v[140:141]
    v_pk_fma_f32 v[66:67], v[142:143], v[68:69], v[70:71]
    v_pk_fma_f32 v[68:69], v[68:69], v[110:111], v[68:69]
    v_pk_fma_f32 v[70:71], v[66:67], v[112:113], v[66:67]
    v_pk_fma_f32 v[66:67], v[144:145], v[68:69], v[70:71]
    v_pk_fma_f32 v[68:69], v[68:69], v[112:113], v[68:69]
    v_pk_fma_f32 v[70:71], v[66:67], v[114:115], v[66:67]
    v_pk_fma_f32 v[66:67], v[146:147], v[68:69], v[70:71]
    v_pk_fma_f32 v[68:69], v[68:69], v[114:115], v[68:69]
    v_pk_fma_f32 v[70:71], v[66:67], v[116:117], v[66:67]
    v_pk_fma_f32 v[66:67], v[148:149], v[68:69], v[70:71]
    v_pk_fma_f32 v[68:69], v[68:69], v[116:117], v[68:69]
    v_pk_fma_f32 v[70:71], v[66:67], v[118:119], v[66:67]
    v_pk_fma_f32 v[66:67], v[150:151], v[68:69], v[70:71]
    v_pk_fma_f32 v[68:69], v[68:69], v[118:119], v[68:69]
    v_pk_fma_f32 v[70:71], v[66:67], v[120:121], v[66:67]
    v_pk_fma_f32 v[66:67], v[152:153], v[68:69], v[70:71]
    v_pk_fma_f32 v[68:69], v[68:69], v[120:121], v[68:69]
    v_pk_fma_f32 v[70:71], v[66:67], v[122:123], v[66:67]
    v_pk_fma_f32 v[66:67], v[154:155], v[68:69], v[70:71]
    v_pk_fma_f32 v[68:69], v[68:69], v[122:123], v[68:69]
    v_max3_f32 v29, v29, v68, v69
    v_mfma_f32_32x32x16_bf16 v[140:155], v[76:79], v[12:15], 0
    v_rcp_f32 v68, v68
    v_rcp_f32 v69, v69
    v_exp_f32_e64 v108, v124
    v_mfma_f32_32x32x16_bf16 v[140:155], v[100:103], v[16:19], v[140:155]
    v_exp_f32 v109, v125
    v_exp_f32 v110, v126
    v_exp_f32_e64 v111, v127
    v_mfma_f32_32x32x16_bf16 v[140:155], v[104:107], v[20:23], v[140:155]
    v_exp_f32 v112, v128
    v_exp_f32 v113, v129
    v_exp_f32_e64 v114, v130
    v_mfma_f32_32x32x8_bf16 v[140:155], v[86:87], v[60:61], v[140:155]
    v_exp_f32 v115, v131
    v_exp_f32 v116, v132
    v_fmac_f32 v73, v66, v68
    v_fmac_f32 v75, v67, v69
    s_setprio 0
    ds_write_b64 v62, v[72:73]
    ds_write_b64 v63, v[74:75]
    s_add_u32 s71, s71, 1
    s_cmp_ge_u32 s71, s70
    s_cbranch_scc1 L_mdone
    s_waitcnt vmcnt(5)
    ds_read_b128 v[92:95], v56 offset:0
    ds_read_b128 v[96:99], v57 offset:0
    ds_read_b128 v[100:103], v58 offset:0
    ds_read_b128 v[104:107], v59 offset:0
    ds_read_b128 v[76:79], v81 offset:512
    ds_read_b64_tr_b16 v[60:61], v30 offset:0
    ds_read_b64 v[72:73], v64
    ds_read_b64 v[74:75], v65
    ds_read_u16 v26, v35 offset:518
    ds_read_b64 v[44:45], v37 offset:64
    ds_read_b32 v32, v36 offset:96
    s_mov_b32 m0, s51
    s_waitcnt lgkmcnt(7)
    s_cmp_lg_u32 s71, s72
    s_cbranch_scc1 L_nw2_1
    buffer_load_dwordx4 v[156:159], v1, s[52:55], s48 offen offset:0 sc1
    buffer_load_dwordx4 v[160:163], v1, s[52:55], s48 offen offset:1024 sc1
    buffer_load_dwordx4 v[164:167], v1, s[52:55], s48 offen offset:2048 sc1
    buffer_load_dwordx4 v[168:171], v1, s[52:55], s48 offen offset:3072 sc1
    buffer_load_dwordx4 v[172:175], v1, s[52:55], s49 offen offset:0 sc1
    buffer_load_dwordx4 v[176:179], v1, s[52:55], s49 offen offset:1024 sc1
    buffer_load_dwordx4 v[180:183], v1, s[52:55], s49 offen offset:2048 sc1
    buffer_load_dwordx4 v[184:187], v1, s[52:55], s49 offen offset:3072 sc1
    s_mov_b64 exec, s[96:97]
    buffer_load_dwordx4 v[214:217], v85, s[36:39], s95 offen offset:16 sc1
    buffer_load_dwordx4 v[210:213], v85, s[36:39], s95 offen sc1
    s_mov_b64 exec, -1
L_nw2_1:
    buffer_load_dwordx4 v[48:49], s[28:31], 0 idxen offen offset:0 sc1 lds
    buffer_load_dwordx4 v[50:51], s[28:31], 0 idxen offen offset:1024 sc1 lds
    buffer_load_dwordx4 v[52:53], s[28:31], 0 idxen offen offset:2048 sc1 lds
    buffer_load_dwordx4 v[54:55], s[28:31], 0 idxen offen offset:3072 sc1 lds
    ds_read_u16 v48, v34 offset:1284
    ds_read_u16 v50, v34 offset:1348
    ds_read_u16 v52, v34 offset:1412
    ds_read_u16 v54, v34 offset:1476
    s_waitcnt lgkmcnt(4)
    .p2align 3
    v_exp_f32 v117, v133
    v_exp_f32 v118, v134
    v_exp_f32 v119, v135
    v_exp_f32 v120, v136
    v_exp_f32 v121, v137
    v_exp_f32 v122, v138
    v_exp_f32 v123, v139
    s_setprio 1
    v_pk_add_f32 v[68:69], v[108:109], 1.0 op_sel_hi:[1,0]
    v_lshlrev_b32 v24, v28, v26
    v_lshlrev_b32 v87, v28, v26
    v_lshl_add_u64 v[62:63], v[44:45], 0, v[42:43]
    v_add_u32_e64 v30, v32, v31
    v_pk_fma_f32 v[70:71], v[124:125], v[110:111], v[124:125]
    v_pk_fma_f32 v[66:67], v[126:127], v[68:69], v[70:71]
    v_pk_fma_f32 v[68:69], v[68:69], v[110:111], v[68:69]
    v_pk_fma_f32 v[70:71], v[66:67], v[112:113], v[66:67]
    v_pk_fma_f32 v[66:67], v[128:129], v[68:69], v[70:71]
    v_pk_fma_f32 v[68:69], v[68:69], v[112:113], v[68:69]
    v_pk_fma_f32 v[70:71], v[66:67], v[114:115], v[66:67]
    v_pk_fma_f32 v[66:67], v[130:131], v[68:69], v[70:71]
    v_pk_fma_f32 v[68:69], v[68:69], v[114:115], v[68:69]
    v_pk_fma_f32 v[70:71], v[66:67], v[116:117], v[66:67]
    v_pk_fma_f32 v[66:67], v[132:133], v[68:69], v[70:71]
    v_pk_fma_f32 v[68:69], v[68:69], v[116:117], v[68:69]
    v_pk_fma_f32 v[70:71], v[66:67], v[118:119], v[66:67]
    v_pk_fma_f32 v[66:67], v[134:135], v[68:69], v[70:71]
    v_pk_fma_f32 v[68:69], v[68:69], v[118:119], v[68:69]
    v_pk_fma_f32 v[70:71], v[66:67], v[120:121], v[66:67]
    v_pk_fma_f32 v[66:67], v[136:137], v[68:69], v[70:71]
    v_pk_fma_f32 v[68:69], v[68:69], v[120:121], v[68:69]
    v_pk_fma_f32 v[70:71], v[66:67], v[122:123], v[66:67]
    v_pk_fma_f32 v[66:67], v[138:139], v[68:69], v[70:71]
    v_pk_fma_f32 v[68:69], v[68:69], v[122:123], v[68:69]
    v_max3_f32 v29, v29, v68, v69
    v_mfma_f32_32x32x16_bf16 v[124:139], v[76:79], v[8:11], 0
    v_rcp_f32 v68, v68
    v_rcp_f32 v69, v69
    v_exp_f32_e64 v108, v140
    v_mfma_f32_32x32x16_bf16 v[124:139], v[92:95], v[16:19], v[124:139]
    v_exp_f32 v109, v141
    v_exp_f32 v110, v142
    v_exp_f32_e64 v111, v143
    v_mfma_f32_32x32x16_bf16 v[124:139], v[96:99], v[20:23], v[124:139]
    v_exp_f32 v112, v144
    v_exp_f32 v113, v145
    v_exp_f32_e64 v114, v146
    v_mfma_f32_32x32x8_bf16 v[124:139], v[24:25], v[60:61], v[124:139]
    v_exp_f32 v115, v147
    v_exp_f32 v116, v148
    v_exp_f32 v117, v149
    v_exp_f32 v118, v150
    v_exp_f32 v119, v151
    v_exp_f32 v120, v152
    v_exp_f32 v121, v153
    v_exp_f32 v122, v154
    v_exp_f32_e64 v123, v155
    v_fmac_f32 v72, v66, v68
    v_fmac_f32 v74, v67, v69
    v_pk_add_f32 v[68:69], v[108:109], 1.0 op_sel_hi:[1,0]
    v_pk_fma_f32 v[70:71], v[140:141], v[110:111], v[140:141]
    v_pk_fma_f32 v[66:67], v[142:143], v[68:69], v[70:71]
    v_pk_fma_f32 v[68:69], v[68:69], v[110:111], v[68:69]
    v_pk_fma_f32 v[70:71], v[66:67], v[112:113], v[66:67]
    v_pk_fma_f32 v[66:67], v[144:145], v[68:69], v[70:71]
    v_pk_fma_f32 v[68:69], v[68:69], v[112:113], v[68:69]
    v_pk_fma_f32 v[70:71], v[66:67], v[114:115], v[66:67]
    v_pk_fma_f32 v[66:67], v[146:147], v[68:69], v[70:71]
    v_pk_fma_f32 v[68:69], v[68:69], v[114:115], v[68:69]
    v_pk_fma_f32 v[70:71], v[66:67], v[116:117], v[66:67]
    v_pk_fma_f32 v[66:67], v[148:149], v[68:69], v[70:71]
    v_pk_fma_f32 v[68:69], v[68:69], v[116:117], v[68:69]
    v_pk_fma_f32 v[70:71], v[66:67], v[118:119], v[66:67]
    v_pk_fma_f32 v[66:67], v[150:151], v[68:69], v[70:71]
    v_pk_fma_f32 v[68:69], v[68:69], v[118:119], v[68:69]
    v_pk_fma_f32 v[70:71], v[66:67], v[120:121], v[66:67]
    v_pk_fma_f32 v[66:67], v[152:153], v[68:69], v[70:71]
    v_pk_fma_f32 v[68:69], v[68:69], v[120:121], v[68:69]
    v_pk_fma_f32 v[70:71], v[66:67], v[122:123], v[66:67]
    v_pk_fma_f32 v[66:67], v[154:155], v[68:69], v[70:71]
    v_pk_fma_f32 v[68:69], v[68:69], v[122:123], v[68:69]
    v_max3_f32 v29, v29, v68, v69
    v_mfma_f32_32x32x16_bf16 v[140:155], v[76:79], v[12:15], 0
    v_rcp_f32 v68, v68
    v_rcp_f32 v69, v69
    v_exp_f32_e64 v108, v124
    v_mfma_f32_32x32x16_bf16 v[140:155], v[100:103], v[16:19], v[140:155]
    v_exp_f32 v109, v125
    v_exp_f32 v110, v126
    v_exp_f32_e64 v111, v127
    v_mfma_f32_32x32x16_bf16 v[140:155], v[104:107], v[20:23], v[140:155]
    v_exp_f32 v112, v128
    v_exp_f32 v113, v129
    v_exp_f32_e64 v114, v130
    v_mfma_f32_32x32x8_bf16 v[140:155], v[86:87], v[60:61], v[140:155]
    v_exp_f32 v115, v131
    v_exp_f32 v116, v132
    v_fmac_f32 v73, v66, v68
    v_fmac_f32 v75, v67, v69
    s_setprio 0
    ds_write_b64 v64, v[72:73]
    ds_write_b64 v65, v[74:75]
    s_add_u32 s71, s71, 1
    s_cmp_ge_u32 s71, s70
    s_cbranch_scc1 L_mdone
    s_waitcnt vmcnt(4)
    ds_read_b128 v[92:95], v56 offset:4096
    ds_read_b128 v[96:99], v57 offset:4096
    ds_read_b128 v[100:103], v58 offset:4096
    ds_read_b128 v[104:107], v59 offset:4096
    ds_read_b128 v[76:79], v81 offset:768
    ds_read_b64_tr_b16 v[60:61], v30 offset:0
    ds_read_b64 v[72:73], v62
    ds_read_b64 v[74:75], v63
    ds_read_u16 v26, v35 offset:774
    ds_read_b64 v[44:45], v37 offset:96
    ds_read_b32 v32, v36 offset:128
    s_mov_b32 m0, s50
    s_waitcnt lgkmcnt(7)
    buffer_load_dwordx4 v[48:49], s[28:31], 0 idxen offen offset:0 sc1 lds
    buffer_load_dwordx4 v[50:51], s[28:31], 0 idxen offen offset:1024 sc1 lds
    buffer_load_dwordx4 v[52:53], s[28:31], 0 idxen offen offset:2048 sc1 lds
    buffer_load_dwordx4 v[54:55], s[28:31], 0 idxen offen offset:3072 sc1 lds
    s_waitcnt lgkmcnt(4)
    s_mov_b64 exec, 1
    ds_add_u32 v83, v200 offset:34192
    s_mov_b64 exec, -1
    ds_read_u16 v48, v34 offset:1540
    ds_read_u16 v50, v34 offset:1604
    ds_read_u16 v52, v34 offset:1668
    ds_read_u16 v54, v34 offset:1732
    ds_read_b32 v46, v80 offset:2048
    s_waitcnt lgkmcnt(5)
    .p2align 3
    v_exp_f32 v117, v133
    v_exp_f32 v118, v134
    v_exp_f32 v119, v135
    v_exp_f32 v120, v136
    v_exp_f32 v121, v137
    v_exp_f32 v122, v138
    v_exp_f32 v123, v139
    s_setprio 1
    v_pk_add_f32 v[68:69], v[108:109], 1.0 op_sel_hi:[1,0]
    v_lshlrev_b32 v24, v28, v26
    v_lshlrev_b32 v87, v28, v26
    v_lshl_add_u64 v[64:65], v[44:45], 0, v[42:43]
    v_add_u32_e64 v30, v32, v31
    v_pk_fma_f32 v[70:71], v[124:125], v[110:111], v[124:125]
    v_pk_fma_f32 v[66:67], v[126:127], v[68:69], v[70:71]
    v_pk_fma_f32 v[68:69], v[68:69], v[110:111], v[68:69]
    v_pk_fma_f32 v[70:71], v[66:67], v[112:113], v[66:67]
    v_pk_fma_f32 v[66:67], v[128:129], v[68:69], v[70:71]
    v_pk_fma_f32 v[68:69], v[68:69], v[112:113], v[68:69]
    v_pk_fma_f32 v[70:71], v[66:67], v[114:115], v[66:67]
    v_pk_fma_f32 v[66:67], v[130:131], v[68:69], v[70:71]
    v_pk_fma_f32 v[68:69], v[68:69], v[114:115], v[68:69]
    v_pk_fma_f32 v[70:71], v[66:67], v[116:117], v[66:67]
    v_pk_fma_f32 v[66:67], v[132:133], v[68:69], v[70:71]
    v_pk_fma_f32 v[68:69], v[68:69], v[116:117], v[68:69]
    v_pk_fma_f32 v[70:71], v[66:67], v[118:119], v[66:67]
    v_pk_fma_f32 v[66:67], v[134:135], v[68:69], v[70:71]
    v_pk_fma_f32 v[68:69], v[68:69], v[118:119], v[68:69]
    v_pk_fma_f32 v[70:71], v[66:67], v[120:121], v[66:67]
    v_pk_fma_f32 v[66:67], v[136:137], v[68:69], v[70:71]
    v_pk_fma_f32 v[68:69], v[68:69], v[120:121], v[68:69]
    v_pk_fma_f32 v[70:71], v[66:67], v[122:123], v[66:67]
    v_pk_fma_f32 v[66:67], v[138:139], v[68:69], v[70:71]
    v_pk_fma_f32 v[68:69], v[68:69], v[122:123], v[68:69]
    v_max3_f32 v29, v29, v68, v69
    v_mfma_f32_32x32x16_bf16 v[124:139], v[76:79], v[8:11], 0
    v_rcp_f32 v68, v68
    v_rcp_f32 v69, v69
    v_exp_f32_e64 v108, v140
    v_mfma_f32_32x32x16_bf16 v[124:139], v[92:95], v[16:19], v[124:139]
    v_exp_f32 v109, v141
    v_exp_f32 v110, v142
    v_exp_f32_e64 v111, v143
    v_mfma_f32_32x32x16_bf16 v[124:139], v[96:99], v[20:23], v[124:139]
    v_exp_f32 v112, v144
    v_exp_f32 v113, v145
    v_exp_f32_e64 v114, v146
    v_mfma_f32_32x32x8_bf16 v[124:139], v[24:25], v[60:61], v[124:139]
    v_exp_f32 v115, v147
    v_exp_f32 v116, v148
    v_exp_f32 v117, v149
    v_exp_f32 v118, v150
    v_exp_f32 v119, v151
    v_exp_f32 v120, v152
    v_exp_f32 v121, v153
    v_exp_f32 v122, v154
    v_exp_f32_e64 v123, v155
    v_fmac_f32 v72, v66, v68
    v_fmac_f32 v74, v67, v69
    v_pk_add_f32 v[68:69], v[108:109], 1.0 op_sel_hi:[1,0]
    v_add_u32_e64 v81, v81, v82
    v_sub_u32_e64 v82, 0, v82
    v_pk_fma_f32 v[70:71], v[140:141], v[110:111], v[140:141]
    v_pk_fma_f32 v[66:67], v[142:143], v[68:69], v[70:71]
    v_pk_fma_f32 v[68:69], v[68:69], v[110:111], v[68:69]
    v_pk_fma_f32 v[70:71], v[66:67], v[112:113], v[66:67]
    v_pk_fma_f32 v[66:67], v[144:145], v[68:69], v[70:71]
    v_pk_fma_f32 v[68:69], v[68:69], v[112:113], v[68:69]
    v_pk_fma_f32 v[70:71], v[66:67], v[114:115], v[66:67]
    v_pk_fma_f32 v[66:67], v[146:147], v[68:69], v[70:71]
    v_pk_fma_f32 v[68:69], v[68:69], v[114:115], v[68:69]
    v_pk_fma_f32 v[70:71], v[66:67], v[116:117], v[66:67]
    v_pk_fma_f32 v[66:67], v[148:149], v[68:69], v[70:71]
    v_pk_fma_f32 v[68:69], v[68:69], v[116:117], v[68:69]
    v_pk_fma_f32 v[70:71], v[66:67], v[118:119], v[66:67]
    v_pk_fma_f32 v[66:67], v[150:151], v[68:69], v[70:71]
    v_pk_fma_f32 v[68:69], v[68:69], v[118:119], v[68:69]
    v_pk_fma_f32 v[70:71], v[66:67], v[120:121], v[66:67]
    v_pk_fma_f32 v[66:67], v[152:153], v[68:69], v[70:71]
    v_pk_fma_f32 v[68:69], v[68:69], v[120:121], v[68:69]
    v_pk_fma_f32 v[70:71], v[66:67], v[122:123], v[66:67]
    v_pk_fma_f32 v[66:67], v[154:155], v[68:69], v[70:71]
    v_pk_fma_f32 v[68:69], v[68:69], v[122:123], v[68:69]
    v_max3_f32 v29, v29, v68, v69
    v_mfma_f32_32x32x16_bf16 v[140:155], v[76:79], v[12:15], 0
    v_rcp_f32 v68, v68
    v_rcp_f32 v69, v69
    v_exp_f32_e64 v108, v124
    v_mfma_f32_32x32x16_bf16 v[140:155], v[100:103], v[16:19], v[140:155]
    v_exp_f32 v109, v125
    v_exp_f32 v110, v126
    v_exp_f32_e64 v111, v127
    v_mfma_f32_32x32x16_bf16 v[140:155], v[104:107], v[20:23], v[140:155]
    v_exp_f32 v112, v128
    v_exp_f32 v113, v129
    v_exp_f32_e64 v114, v130
    v_mfma_f32_32x32x8_bf16 v[140:155], v[86:87], v[60:61], v[140:155]
    v_exp_f32 v115, v131
    v_exp_f32 v116, v132
    v_fmac_f32 v73, v66, v68
    v_fmac_f32 v75, v67, v69
    s_setprio 0
    ds_write_b64 v62, v[72:73]
    ds_write_b64 v63, v[74:75]
    s_add_u32 s71, s71, 1
    s_cmp_ge_u32 s71, s70
    s_cbranch_scc1 L_mdone
    ds_read_b32 v84, v83 offset:34192
    s_waitcnt vmcnt(4)
    ds_read_b128 v[92:95], v56 offset:0
    ds_read_b128 v[96:99], v57 offset:0
    ds_read_b128 v[100:103], v58 offset:0
    ds_read_b128 v[104:107], v59 offset:0
    ds_read_b64_tr_b16 v[60:61], v30 offset:0
    ds_read_b64 v[72:73], v64
    ds_read_b64 v[74:75], v65
    ds_read_u16 v26, v35 offset:1030
    ds_read_b64 v[44:45], v37 offset:128
    ds_read_b32 v32, v36 offset:160
    s_mov_b32 m0, s51
    s_waitcnt lgkmcnt(6)
    buffer_load_dwordx4 v[48:49], s[28:31], 0 idxen offen offset:0 sc1 lds
    buffer_load_dwordx4 v[50:51], s[28:31], 0 idxen offen offset:1024 sc1 lds
    buffer_load_dwordx4 v[52:53], s[28:31], 0 idxen offen offset:2048 sc1 lds
    buffer_load_dwordx4 v[54:55], s[28:31], 0 idxen offen offset:3072 sc1 lds
    s_setprio 2
L_chk_2:
    v_cmp_gt_u32 vcc, s88, v84
    s_cbranch_vccz L_go_3
    ds_read_b32 v84, v83 offset:34192
    s_waitcnt lgkmcnt(0)
    s_branch L_chk_2
L_go_3:
    s_setprio 0
    ds_read_b128 v[76:79], v81 offset:0
    s_mov_b32 m0, s23
    s_add_u32 s23, s23, s89
    buffer_load_dwordx4 v[46:47], s[32:35], 0 idxen offen  lds
    s_sub_u32 s89, 0, s89
    s_add_u32 s88, s88, 4
    ds_read_u16 v48, v34 offset:1796
    ds_read_u16 v50, v34 offset:1860
    ds_read_u16 v52, v34 offset:1924
    ds_read_u16 v54, v34 offset:1988
    s_waitcnt lgkmcnt(4)
    .p2align 3
    v_exp_f32 v117, v133
    v_exp_f32 v118, v134
    v_exp_f32 v119, v135
    v_exp_f32 v120, v136
    v_exp_f32 v121, v137
    v_exp_f32 v122, v138
    v_exp_f32 v123, v139
    s_setprio 1
    v_pk_add_f32 v[68:69], v[108:109], 1.0 op_sel_hi:[1,0]
    v_lshlrev_b32 v24, v28, v26
    v_lshlrev_b32 v87, v28, v26
    v_lshl_add_u64 v[62:63], v[44:45], 0, v[42:43]
    v_add_u32_e64 v30, v32, v31
    v_pk_fma_f32 v[70:71], v[124:125], v[110:111], v[124:125]
    v_pk_fma_f32 v[66:67], v[126:127], v[68:69], v[70:71]
    v_pk_fma_f32 v[68:69], v[68:69], v[110:111], v[68:69]
    v_pk_fma_f32 v[70:71], v[66:67], v[112:113], v[66:67]
    v_pk_fma_f32 v[66:67], v[128:129], v[68:69], v[70:71]
    v_pk_fma_f32 v[68:69], v[68:69], v[112:113], v[68:69]
    v_pk_fma_f32 v[70:71], v[66:67], v[114:115], v[66:67]
    v_pk_fma_f32 v[66:67], v[130:131], v[68:69], v[70:71]
    v_pk_fma_f32 v[68:69], v[68:69], v[114:115], v[68:69]
    v_pk_fma_f32 v[70:71], v[66:67], v[116:117], v[66:67]
    v_pk_fma_f32 v[66:67], v[132:133], v[68:69], v[70:71]
    v_pk_fma_f32 v[68:69], v[68:69], v[116:117], v[68:69]
    v_pk_fma_f32 v[70:71], v[66:67], v[118:119], v[66:67]
    v_pk_fma_f32 v[66:67], v[134:135], v[68:69], v[70:71]
    v_pk_fma_f32 v[68:69], v[68:69], v[118:119], v[68:69]
    v_pk_fma_f32 v[70:71], v[66:67], v[120:121], v[66:67]
    v_pk_fma_f32 v[66:67], v[136:137], v[68:69], v[70:71]
    v_pk_fma_f32 v[68:69], v[68:69], v[120:121], v[68:69]
    v_pk_fma_f32 v[70:71], v[66:67], v[122:123], v[66:67]
    v_pk_fma_f32 v[66:67], v[138:139], v[68:69], v[70:71]
    v_pk_fma_f32 v[68:69], v[68:69], v[122:123], v[68:69]
    v_max3_f32 v29, v29, v68, v69
    v_mfma_f32_32x32x16_bf16 v[124:139], v[76:79], v[8:11], 0
    v_rcp_f32 v68, v68
    v_rcp_f32 v69, v69
    v_exp_f32_e64 v108, v140
    v_mfma_f32_32x32x16_bf16 v[124:139], v[92:95], v[16:19], v[124:139]
    v_exp_f32 v109, v141
    v_exp_f32 v110, v142
    v_exp_f32_e64 v111, v143
    v_mfma_f32_32x32x16_bf16 v[124:139], v[96:99], v[20:23], v[124:139]
    v_exp_f32 v112, v144
    v_exp_f32 v113, v145
    v_exp_f32_e64 v114, v146
    v_mfma_f32_32x32x8_bf16 v[124:139], v[24:25], v[60:61], v[124:139]
    v_exp_f32 v115, v147
    v_exp_f32 v116, v148
    v_exp_f32 v117, v149
    v_exp_f32 v118, v150
    v_exp_f32 v119, v151
    v_exp_f32 v120, v152
    v_exp_f32 v121, v153
    v_exp_f32 v122, v154
    v_exp_f32_e64 v123, v155
    v_fmac_f32 v72, v66, v68
    v_fmac_f32 v74, v67, v69
    v_pk_add_f32 v[68:69], v[108:109], 1.0 op_sel_hi:[1,0]
    v_lshl_add_u64 v[34:35], v[34:35], 0, v[38:39]
    v_lshl_add_u64 v[36:37], v[36:37], 0, v[40:41]
    v_add_u32_e64 v80, v80, v38
    v_pk_fma_f32 v[70:71], v[140:141], v[110:111], v[140:141]
    v_pk_fma_f32 v[66:67], v[142:143], v[68:69], v[70:71]
    v_pk_fma_f32 v[68:69], v[68:69], v[110:111], v[68:69]
    v_pk_fma_f32 v[70:71], v[66:67], v[112:113], v[66:67]
    v_pk_fma_f32 v[66:67], v[144:145], v[68:69], v[70:71]
    v_pk_fma_f32 v[68:69], v[68:69], v[112:113], v[68:69]
    v_pk_fma_f32 v[70:71], v[66:67], v[114:115], v[66:67]
    v_pk_fma_f32 v[66:67], v[146:147], v[68:69], v[70:71]
    v_pk_fma_f32 v[68:69], v[68:69], v[114:115], v[68:69]
    v_pk_fma_f32 v[70:71], v[66:67], v[116:117], v[66:67]
    v_pk_fma_f32 v[66:67], v[148:149], v[68:69], v[70:71]
    v_pk_fma_f32 v[68:69], v[68:69], v[116:117], v[68:69]
    v_pk_fma_f32 v[70:71], v[66:67], v[118:119], v[66:67]
    v_pk_fma_f32 v[66:67], v[150:151], v[68:69], v[70:71]
    v_pk_fma_f32 v[68:69], v[68:69], v[118:119], v[68:69]
    v_pk_fma_f32 v[70:71], v[66:67], v[120:121], v[66:67]
    v_pk_fma_f32 v[66:67], v[152:153], v[68:69], v[70:71]
    v_pk_fma_f32 v[68:69], v[68:69], v[120:121], v[68:69]
    v_pk_fma_f32 v[70:71], v[66:67], v[122:123], v[66:67]
    v_pk_fma_f32 v[66:67], v[154:155], v[68:69], v[70:71]
    v_pk_fma_f32 v[68:69], v[68:69], v[122:123], v[68:69]
    v_max3_f32 v29, v29, v68, v69
    v_mfma_f32_32x32x16_bf16 v[140:155], v[76:79], v[12:15], 0
    v_rcp_f32 v68, v68
    v_rcp_f32 v69, v69
    v_exp_f32_e64 v108, v124
    v_mfma_f32_32x32x16_bf16 v[140:155], v[100:103], v[16:19], v[140:155]
    v_exp_f32 v109, v125
    v_exp_f32 v110, v126
    v_exp_f32_e64 v111, v127
    v_mfma_f32_32x32x16_bf16 v[140:155], v[104:107], v[20:23], v[140:155]
    v_exp_f32 v112, v128
    v_exp_f32 v113, v129
    v_exp_f32_e64 v114, v130
    v_mfma_f32_32x32x8_bf16 v[140:155], v[86:87], v[60:61], v[140:155]
    v_exp_f32 v115, v131
    v_exp_f32 v116, v132
    v_fmac_f32 v73, v66, v68
    v_fmac_f32 v75, v67, v69
    s_setprio 0
    ds_write_b64 v64, v[72:73]
    ds_write_b64 v65, v[74:75]
    s_add_u32 s71, s71, 1
    s_cmp_ge_u32 s71, s70
    s_cbranch_scc1 L_mdone
    s_waitcnt vmcnt(5)
    ds_read_b128 v[92:95], v56 offset:4096
    ds_read_b128 v[96:99], v57 offset:4096
    ds_read_b128 v[100:103], v58 offset:4096
    ds_read_b128 v[104:107], v59 offset:4096
    ds_read_b128 v[76:79], v81 offset:256
    ds_read_b64_tr_b16 v[60:61], v30 offset:0
    ds_read_b64 v[72:73], v62
    ds_read_b64 v[74:75], v63
    ds_read_u16 v26, v35 offset:262
    ds_read_b64 v[44:45], v37 offset:32
    ds_read_b32 v32, v36 offset:64
    s_mov_b32 m0, s50
    s_waitcnt lgkmcnt(7)
    buffer_load_dwordx4 v[48:49], s[28:31], 0 idxen offen offset:0 sc1 lds
    buffer_load_dwordx4 v[50:51], s[28:31], 0 idxen offen offset:1024 sc1 lds
    buffer_load_dwordx4 v[52:53], s[28:31], 0 idxen offen offset:2048 sc1 lds
    buffer_load_dwordx4 v[54:55], s[28:31], 0 idxen offen offset:3072 sc1 lds
    ds_read_u16 v48, v34 offset:1028
    ds_read_u16 v50, v34 offset:1092
    ds_read_u16 v52, v34 offset:1156
    ds_read_u16 v54, v34 offset:1220
    s_waitcnt lgkmcnt(4)
    s_branch L_loop
L_mdone:
    s_cmp_gt_u32 s70, s72
    s_cbranch_scc1 L_havew2
    buffer_load_dwordx4 v[156:159], v1, s[52:55], s48 offen offset:0 sc1
    buffer_load_dwordx4 v[160:163], v1, s[52:55], s48 offen offset:1024 sc1
    buffer_load_dwordx4 v[164:167], v1, s[52:55], s48 offen offset:2048 sc1
    buffer_load_dwordx4 v[168:171], v1, s[52:55], s48 offen offset:3072 sc1
    buffer_load_dwordx4 v[172:175], v1, s[52:55], s49 offen offset:0 sc1
    buffer_load_dwordx4 v[176:179], v1, s[52:55], s49 offen offset:1024 sc1
    buffer_load_dwordx4 v[180:183], v1, s[52:55], s49 offen offset:2048 sc1
    buffer_load_dwordx4 v[184:187], v1, s[52:55], s49 offen offset:3072 sc1
    s_mov_b64 exec, s[96:97]
    buffer_load_dwordx4 v[214:217], v85, s[36:39], s95 offen offset:16 sc1
    buffer_load_dwordx4 v[210:213], v85, s[36:39], s95 offen sc1
    s_mov_b64 exec, -1
L_havew2:
    ds_read_b128 v[108:111], v201
    ds_read_b128 v[112:115], v202
    ds_read_b128 v[116:119], v203
    ds_read_b128 v[120:123], v204
    ds_read_b128 v[124:127], v205
    s_mov_b32 s44, s24
    s_mov_b32 s45, s25
    s_mov_b32 s46, 2560000
    s_mov_b32 s47, 0x00020000
    v_mov_b32 v14, 0
    v_mov_b32 v15, 0
    v_mov_b32 v19, 0
    v_mul_u32_u24 v17, 1552, v4
    v_lshl_add_u32 v17, v3, 4, v17
    v_add_u32 v17, 36784, v17
    v_lshlrev_b32 v16, 8, v4
    v_lshl_add_u32 v16, v3, 3, v16
    s_mul_i32 s48, s2, 10240
    s_lshl_b32 s49, s22, 5
    s_add_u32 s48, s48, s49
    s_add_u32 s49, s48, 8192
    s_add_u32 s41, s48, 4096
    s_mov_b32 s50, 0xbf317218
    s_mov_b32 s51, s50
    s_mov_b32 s40, 0x7b800000
    s_waitcnt lgkmcnt(4)
    v_cvt_pk_bf16_f32 v20, v108, v109
    v_cvt_pk_bf16_f32 v21, v110, v111
    ds_write_b64 v218, v[20:21] offset:1024
    s_waitcnt lgkmcnt(4)
    v_cvt_pk_bf16_f32 v22, v112, v113
    v_cvt_pk_bf16_f32 v23, v114, v115
    ds_write_b64 v219, v[22:23] offset:1024
    s_waitcnt lgkmcnt(4)
    v_cvt_pk_bf16_f32 v20, v116, v117
    v_cvt_pk_bf16_f32 v21, v118, v119
    ds_write_b64 v220, v[20:21] offset:1024
    s_waitcnt lgkmcnt(4)
    v_cvt_pk_bf16_f32 v22, v120, v121
    v_cvt_pk_bf16_f32 v23, v122, v123
    ds_write_b64 v221, v[22:23] offset:1024
    s_waitcnt lgkmcnt(4)
    v_cvt_pk_bf16_f32 v20, v124, v125
    v_cvt_pk_bf16_f32 v21, v126, v127
    ds_write_b64 v222, v[20:21] offset:1024
    v_pk_fma_f32 v[14:15], v[108:109], 0, v[14:15] op_sel_hi:[1,0,1]
    v_pk_fma_f32 v[14:15], v[110:111], 0, v[14:15] op_sel_hi:[1,0,1]
    v_pk_fma_f32 v[14:15], v[112:113], 0, v[14:15] op_sel_hi:[1,0,1]
    v_pk_fma_f32 v[14:15], v[114:115], 0, v[14:15] op_sel_hi:[1,0,1]
    v_pk_fma_f32 v[14:15], v[116:117], 0, v[14:15] op_sel_hi:[1,0,1]
    v_pk_fma_f32 v[14:15], v[118:119], 0, v[14:15] op_sel_hi:[1,0,1]
    v_pk_fma_f32 v[14:15], v[120:121], 0, v[14:15] op_sel_hi:[1,0,1]
    v_pk_fma_f32 v[14:15], v[122:123], 0, v[14:15] op_sel_hi:[1,0,1]
    v_pk_fma_f32 v[14:15], v[124:125], 0, v[14:15] op_sel_hi:[1,0,1]
    v_pk_fma_f32 v[14:15], v[126:127], 0, v[14:15] op_sel_hi:[1,0,1]
    v_cmp_u_f32 vcc, v14, v15
    v_cmp_nlt_f32 s[42:43], v29, s40
    s_or_b64 vcc, vcc, s[42:43]
    s_waitcnt vmcnt(0)
    v_cmp_ne_u64 s[60:61], v[188:189], v[210:211]
    v_cmp_ne_u64 s[62:63], v[190:191], v[212:213]
    v_cmp_ne_u64 s[64:65], v[192:193], v[214:215]
    v_cmp_ne_u64 s[66:67], v[194:195], v[216:217]
    s_or_b64 vcc, vcc, s[60:61]
    s_or_b64 vcc, vcc, s[62:63]
    s_or_b64 vcc, vcc, s[64:65]
    s_or_b64 vcc, vcc, s[66:67]
    s_cbranch_vccz L_noflag
    ds_write_b32 v19, v200 offset:34180
L_noflag:
    s_waitcnt lgkmcnt(0)
    s_barrier
    ds_read_b32 v14, v19 offset:34180
    ds_read_b128 v[32:35], v17 offset:0
    ds_read_b128 v[64:67], v17 offset:24832
    ds_read_b128 v[96:99], v17 offset:49664
    ds_read_b128 v[36:39], v17 offset:64
    ds_read_b128 v[68:71], v17 offset:24896
    ds_read_b128 v[100:103], v17 offset:49728
    s_waitcnt lgkmcnt(6)
    v_readfirstlane_b32 s72, v14
    ds_read_b128 v[40:43], v17 offset:128
    ds_read_b128 v[72:75], v17 offset:24960
    ds_read_b128 v[104:107], v17 offset:49792
    s_andn2_b32 s72, s72, s73
    s_cbranch_scc1 L_slow
    ds_read_b128 v[44:47], v17 offset:192
    ds_read_b128 v[76:79], v17 offset:25024
    ds_read_b128 v[108:111], v17 offset:49856
    ds_read_b128 v[48:51], v17 offset:256
    ds_read_b128 v[80:83], v17 offset:25088
    ds_read_b128 v[112:115], v17 offset:49920
    ds_read_b128 v[52:55], v17 offset:320
    ds_read_b128 v[84:87], v17 offset:25152
    ds_read_b128 v[116:119], v17 offset:49984
    ds_read_b128 v[56:59], v17 offset:384
    ds_read_b128 v[88:91], v17 offset:25216
    ds_read_b128 v[120:123], v17 offset:50048
    ds_read_b128 v[60:63], v17 offset:448
    ds_read_b128 v[92:95], v17 offset:25280
    ds_read_b128 v[124:127], v17 offset:50112
    s_waitcnt lgkmcnt(15)
    v_mfma_f32_16x16x32_bf16 v[128:131], v[156:159], v[32:35], v[234:237]
    v_mfma_f32_16x16x32_bf16 v[132:135], v[156:159], v[64:67], v[238:241]
    v_mfma_f32_16x16x32_bf16 v[136:139], v[156:159], v[96:99], v[242:245]
    s_waitcnt lgkmcnt(15)
    v_mfma_f32_16x16x32_bf16 v[128:131], v[160:163], v[36:39], v[128:131]
    v_mfma_f32_16x16x32_bf16 v[132:135], v[160:163], v[68:71], v[132:135]
    v_mfma_f32_16x16x32_bf16 v[136:139], v[160:163], v[100:103], v[136:139]
    s_waitcnt lgkmcnt(15)
    v_mfma_f32_16x16x32_bf16 v[128:131], v[164:167], v[40:43], v[128:131]
    v_mfma_f32_16x16x32_bf16 v[132:135], v[164:167], v[72:75], v[132:135]
    v_mfma_f32_16x16x32_bf16 v[136:139], v[164:167], v[104:107], v[136:139]
    s_waitcnt lgkmcnt(12)
    v_mfma_f32_16x16x32_bf16 v[128:131], v[168:171], v[44:47], v[128:131]
    v_mfma_f32_16x16x32_bf16 v[132:135], v[168:171], v[76:79], v[132:135]
    v_mfma_f32_16x16x32_bf16 v[136:139], v[168:171], v[108:111], v[136:139]
    s_waitcnt lgkmcnt(9)
    v_mfma_f32_16x16x32_bf16 v[128:131], v[172:175], v[48:51], v[128:131]
    v_mfma_f32_16x16x32_bf16 v[132:135], v[172:175], v[80:83], v[132:135]
    v_mfma_f32_16x16x32_bf16 v[136:139], v[172:175], v[112:115], v[136:139]
    s_waitcnt lgkmcnt(6)
    v_mfma_f32_16x16x32_bf16 v[128:131], v[176:179], v[52:55], v[128:131]
    v_mfma_f32_16x16x32_bf16 v[132:135], v[176:179], v[84:87], v[132:135]
    v_mfma_f32_16x16x32_bf16 v[136:139], v[176:179], v[116:119], v[136:139]
    s_waitcnt lgkmcnt(3)
    v_mfma_f32_16x16x32_bf16 v[128:131], v[180:183], v[56:59], v[128:131]
    v_mfma_f32_16x16x32_bf16 v[132:135], v[180:183], v[88:91], v[132:135]
    v_mfma_f32_16x16x32_bf16 v[136:139], v[180:183], v[120:123], v[136:139]
    s_waitcnt lgkmcnt(0)
    v_mfma_f32_16x16x32_bf16 v[128:131], v[184:187], v[60:63], v[128:131]
    v_mfma_f32_16x16x32_bf16 v[132:135], v[184:187], v[92:95], v[132:135]
    v_mfma_f32_16x16x32_bf16 v[136:139], v[184:187], v[124:127], v[136:139]
    s_nop 5
    v_pk_mul_f32 v[128:129], v[128:129], s[50:51]
    v_pk_mul_f32 v[130:131], v[130:131], s[50:51]
    v_cvt_pk_bf16_f32 v128, v128, v129
    v_cvt_pk_bf16_f32 v129, v130, v131
    buffer_store_dwordx2 v[128:129], v16, s[44:47], s48 offen
    v_pk_mul_f32 v[132:133], v[132:133], s[50:51]
    v_pk_mul_f32 v[134:135], v[134:135], s[50:51]
    v_cvt_pk_bf16_f32 v132, v132, v133
    v_cvt_pk_bf16_f32 v133, v134, v135
    buffer_store_dwordx2 v[132:133], v16, s[44:47], s41 offen
    v_pk_mul_f32 v[136:137], v[136:137], s[50:51]
    v_pk_mul_f32 v[138:139], v[138:139], s[50:51]
    v_cvt_pk_bf16_f32 v136, v136, v137
    v_cvt_pk_bf16_f32 v137, v138, v139
    s_mov_b32 exec_lo, 0x00ff00ff
    s_mov_b32 exec_hi, 0x00ff00ff
    buffer_store_dwordx2 v[136:137], v16, s[44:47], s49 offen
    s_or_b32 s40, s82, s22
    s_cbranch_scc1 L_noep
    s_mov_b64 exec, 1
    v_mov_b32 v24, s80
    v_mov_b32 v25, s81
    v_mov_b32 v26, 24576
    buffer_store_dwordx2 v[24:25], v26, s[76:79], 0 offen
L_noep:
L_end:
L_done:
    s_endpgm
L_prep:
    s_add_u32 s84, s20, 9592832
    s_addc_u32 s85, s21, 0
    s_load_dwordx2 s[86:87], s[84:85], 0
    s_add_u32 s76, s20, 9568256
    s_addc_u32 s77, s21, 0
    s_mov_b32 s78, 32768
    s_mov_b32 s79, 0x00020000
    s_add_u32 s40, s20, 9437184
    s_addc_u32 s41, s21, 0
    s_mov_b32 s42, 73728
    s_mov_b32 s43, 0x00020000
    s_cmp_eq_u32 s2, 252
    s_cbranch_scc1 L_w1c
    s_mov_b32 s52, s16
    s_mov_b32 s53, s17
    s_mov_b32 s54, 65536
    s_mov_b32 s55, 0x00020000
    s_and_b32 s45, s2, 1
    s_lshl_b32 s44, s45, 15
    s_lshl_b32 s48, s22, 5
    s_add_u32 s44, s44, s48
    v_lshlrev_b32 v96, 1, v4
    v_lshl_add_u32 v96, v3, 10, v96
    v_add_u32 v97, 8192, v96
    buffer_load_ushort v108, v96, s[52:55], s44 offen offset:0
    buffer_load_ushort v109, v97, s[52:55], s44 offen offset:0
    buffer_load_ushort v110, v96, s[52:55], s44 offen offset:256
    buffer_load_ushort v111, v97, s[52:55], s44 offen offset:256
    buffer_load_ushort v112, v96, s[52:55], s44 offen offset:512
    buffer_load_ushort v113, v97, s[52:55], s44 offen offset:512
    buffer_load_ushort v114, v96, s[52:55], s44 offen offset:768
    buffer_load_ushort v115, v97, s[52:55], s44 offen offset:768
    s_add_u32 s44, s44, 4096
    buffer_load_ushort v116, v96, s[52:55], s44 offen offset:0
    buffer_load_ushort v117, v97, s[52:55], s44 offen offset:0
    buffer_load_ushort v118, v96, s[52:55], s44 offen offset:256
    buffer_load_ushort v119, v97, s[52:55], s44 offen offset:256
    buffer_load_ushort v120, v96, s[52:55], s44 offen offset:512
    buffer_load_ushort v121, v97, s[52:55], s44 offen offset:512
    buffer_load_ushort v122, v96, s[52:55], s44 offen offset:768
    buffer_load_ushort v123, v97, s[52:55], s44 offen offset:768
    s_add_u32 s44, s44, 12288
    buffer_load_ushort v124, v96, s[52:55], s44 offen offset:0
    buffer_load_ushort v125, v97, s[52:55], s44 offen offset:0
    buffer_load_ushort v126, v96, s[52:55], s44 offen offset:256
    buffer_load_ushort v127, v97, s[52:55], s44 offen offset:256
    buffer_load_ushort v128, v96, s[52:55], s44 offen offset:512
    buffer_load_ushort v129, v97, s[52:55], s44 offen offset:512
    buffer_load_ushort v130, v96, s[52:55], s44 offen offset:768
    buffer_load_ushort v131, v97, s[52:55], s44 offen offset:768
    s_add_u32 s44, s44, 4096
    buffer_load_ushort v132, v96, s[52:55], s44 offen offset:0
    buffer_load_ushort v133, v97, s[52:55], s44 offen offset:0
    buffer_load_ushort v134, v96, s[52:55], s44 offen offset:256
    buffer_load_ushort v135, v97, s[52:55], s44 offen offset:256
    buffer_load_ushort v136, v96, s[52:55], s44 offen offset:512
    buffer_load_ushort v137, v97, s[52:55], s44 offen offset:512
    buffer_load_ushort v138, v96, s[52:55], s44 offen offset:768
    buffer_load_ushort v139, v97, s[52:55], s44 offen offset:768
    s_add_u32 s44, s44, 12288
    s_lshl_b32 s45, s45, 12
    s_add_u32 s45, s45, s47
    s_waitcnt vmcnt(0)
    v_lshl_or_b32 v140, v109, 16, v108
    v_lshl_or_b32 v141, v111, 16, v110
    v_lshl_or_b32 v142, v113, 16, v112
    v_lshl_or_b32 v143, v115, 16, v114
    v_lshl_or_b32 v144, v117, 16, v116
    v_lshl_or_b32 v145, v119, 16, v118
    v_lshl_or_b32 v146, v121, 16, v120
    v_lshl_or_b32 v147, v123, 16, v122
    v_lshl_or_b32 v148, v125, 16, v124
    v_lshl_or_b32 v149, v127, 16, v126
    v_lshl_or_b32 v150, v129, 16, v128
    v_lshl_or_b32 v151, v131, 16, v130
    v_lshl_or_b32 v152, v133, 16, v132
    v_lshl_or_b32 v153, v135, 16, v134
    v_lshl_or_b32 v154, v137, 16, v136
    v_lshl_or_b32 v155, v139, 16, v138
    buffer_store_dwordx4 v[140:143], v1, s[40:43], s45 offen offset:0 sc1
    buffer_store_dwordx4 v[144:147], v1, s[40:43], s45 offen offset:1024 sc1
    buffer_store_dwordx4 v[148:151], v1, s[40:43], s45 offen offset:2048 sc1
    buffer_store_dwordx4 v[152:155], v1, s[40:43], s45 offen offset:3072 sc1
L_prepflag:
    s_waitcnt lgkmcnt(0)
    s_mul_i32 s80, s86, 1664525
    s_add_u32 s80, s80, 1013904223
    s_mul_i32 s81, s87, 22695477
    s_add_u32 s81, s81, 1
    s_lshl_b32 s45, s2, 3
    s_add_u32 s45, s45, 8192
    s_waitcnt vmcnt(0)
    s_barrier
    s_cmp_lg_u32 s22, 0
    s_cbranch_scc1 L_end
    v_mov_b32 v76, s80
    v_mov_b32 v77, s81
    v_lshlrev_b32 v78, 11, v2
    s_mov_b64 exec, 0xff
    buffer_store_dwordx2 v[76:77], v78, s[76:79], s45 offen sc1
    s_mov_b64 exec, -1
L_nofp:
    s_branch L_end
L_w1c:
    s_mov_b32 s52, s12
    s_mov_b32 s53, s13
    s_mov_b32 s54, 139264
    s_mov_b32 s55, 0x00020000
    v_lshlrev_b32 v100, 1, v5
    v_lshl_add_u32 v100, v6, 12, v100
    s_lshl_b32 s45, s22, 6
    s_add_u32 s45, s45, 131072
    buffer_load_ushort v108, v100, s[52:55], s45 offen offset:0
    buffer_load_ushort v109, v100, s[52:55], s45 offen offset:512
    buffer_load_ushort v110, v100, s[52:55], s45 offen offset:1024
    buffer_load_ushort v111, v100, s[52:55], s45 offen offset:1536
    buffer_load_ushort v112, v100, s[52:55], s45 offen offset:2048
    buffer_load_ushort v113, v100, s[52:55], s45 offen offset:2560
    buffer_load_ushort v114, v100, s[52:55], s45 offen offset:3072
    buffer_load_ushort v115, v100, s[52:55], s45 offen offset:3584
    s_mov_b32 s44, 0xbfb8aa3b
    v_lshlrev_b32 v101, 4, v0
    s_mov_b32 s45, 65536
    s_waitcnt vmcnt(0)
    v_lshlrev_b32 v108, 16, v108
    v_mul_f32 v108, s44, v108
    v_lshlrev_b32 v109, 16, v109
    v_mul_f32 v109, s44, v109
    v_lshlrev_b32 v110, 16, v110
    v_mul_f32 v110, s44, v110
    v_lshlrev_b32 v111, 16, v111
    v_mul_f32 v111, s44, v111
    v_lshlrev_b32 v112, 16, v112
    v_mul_f32 v112, s44, v112
    v_lshlrev_b32 v113, 16, v113
    v_mul_f32 v113, s44, v113
    v_lshlrev_b32 v114, 16, v114
    v_mul_f32 v114, s44, v114
    v_lshlrev_b32 v115, 16, v115
    v_mul_f32 v115, s44, v115
    v_cvt_pk_bf16_f32 v116, v108, v109
    v_cvt_pk_bf16_f32 v117, v110, v111
    v_cvt_pk_bf16_f32 v118, v112, v113
    v_cvt_pk_bf16_f32 v119, v114, v115
    buffer_store_dwordx4 v[116:119], v101, s[40:43], s45 offen sc1
    s_branch L_prepflag
L_slow:
    s_mov_b32 s73, 1
    v_mov_b32 v29, 0
    s_waitcnt vmcnt(0) lgkmcnt(0)
    s_barrier
    s_mov_b32 s36, s12
    s_mov_b32 s37, s13
    s_mov_b32 s38, 139264
    s_mov_b32 s39, 0x00020000
    s_mov_b32 s44, s16
    s_mov_b32 s45, s17
    s_mov_b32 s46, 65536
    s_mov_b32 s47, 0x00020000
    s_mov_b32 s56, s10
    s_mov_b32 s57, s11
    s_mov_b32 s58, 1280000
    s_mov_b32 s59, 0x00020000
    s_mov_b32 s60, s8
    s_mov_b32 s61, s9
    s_mov_b32 s62, 1280000
    s_mov_b32 s63, 0x00020000
    s_mov_b32 s52, s14
    s_mov_b32 s53, s15
    s_mov_b32 s54, 512
    s_mov_b32 s55, 0x00020000
    v_lshlrev_b32 v96, 1, v4
    v_lshl_add_u32 v96, v3, 10, v96
    v_add_u32 v97, 8192, v96
    s_lshl_b32 s40, s22, 5
    buffer_load_ushort v124, v96, s[44:47], s40 offen offset:0
    buffer_load_ushort v125, v97, s[44:47], s40 offen offset:0
    buffer_load_ushort v126, v96, s[44:47], s40 offen offset:256
    buffer_load_ushort v127, v97, s[44:47], s40 offen offset:256
    buffer_load_ushort v128, v96, s[44:47], s40 offen offset:512
    buffer_load_ushort v129, v97, s[44:47], s40 offen offset:512
    buffer_load_ushort v130, v96, s[44:47], s40 offen offset:768
    buffer_load_ushort v131, v97, s[44:47], s40 offen offset:768
    s_add_u32 s40, s40, 4096
    s_waitcnt vmcnt(0)
    v_lshl_or_b32 v156, v125, 16, v124
    v_lshl_or_b32 v157, v127, 16, v126
    v_lshl_or_b32 v158, v129, 16, v128
    v_lshl_or_b32 v159, v131, 16, v130
    buffer_load_ushort v124, v96, s[44:47], s40 offen offset:0
    buffer_load_ushort v125, v97, s[44:47], s40 offen offset:0
    buffer_load_ushort v126, v96, s[44:47], s40 offen offset:256
    buffer_load_ushort v127, v97, s[44:47], s40 offen offset:256
    buffer_load_ushort v128, v96, s[44:47], s40 offen offset:512
    buffer_load_ushort v129, v97, s[44:47], s40 offen offset:512
    buffer_load_ushort v130, v96, s[44:47], s40 offen offset:768
    buffer_load_ushort v131, v97, s[44:47], s40 offen offset:768
    s_add_u32 s40, s40, 12288
    s_waitcnt vmcnt(0)
    v_lshl_or_b32 v160, v125, 16, v124
    v_lshl_or_b32 v161, v127, 16, v126
    v_lshl_or_b32 v162, v129, 16, v128
    v_lshl_or_b32 v163, v131, 16, v130
    buffer_load_ushort v124, v96, s[44:47], s40 offen offset:0
    buffer_load_ushort v125, v97, s[44:47], s40 offen offset:0
    buffer_load_ushort v126, v96, s[44:47], s40 offen offset:256
    buffer_load_ushort v127, v97, s[44:47], s40 offen offset:256
    buffer_load_ushort v128, v96, s[44:47], s40 offen offset:512
    buffer_load_ushort v129, v97, s[44:47], s40 offen offset:512
    buffer_load_ushort v130, v96, s[44:47], s40 offen offset:768
    buffer_load_ushort v131, v97, s[44:47], s40 offen offset:768
    s_add_u32 s40, s40, 4096
    s_waitcnt vmcnt(0)
    v_lshl_or_b32 v164, v125, 16, v124
    v_lshl_or_b32 v165, v127, 16, v126
    v_lshl_or_b32 v166, v129, 16, v128
    v_lshl_or_b32 v167, v131, 16, v130
    buffer_load_ushort v124, v96, s[44:47], s40 offen offset:0
    buffer_load_ushort v125, v97, s[44:47], s40 offen offset:0
    buffer_load_ushort v126, v96, s[44:47], s40 offen offset:256
    buffer_load_ushort v127, v97, s[44:47], s40 offen offset:256
    buffer_load_ushort v128, v96, s[44:47], s40 offen offset:512
    buffer_load_ushort v129, v97, s[44:47], s40 offen offset:512
    buffer_load_ushort v130, v96, s[44:47], s40 offen offset:768
    buffer_load_ushort v131, v97, s[44:47], s40 offen offset:768
    s_add_u32 s40, s40, 12288
    s_waitcnt vmcnt(0)
    v_lshl_or_b32 v168, v125, 16, v124
    v_lshl_or_b32 v169, v127, 16, v126
    v_lshl_or_b32 v170, v129, 16, v128
    v_lshl_or_b32 v171, v131, 16, v130
    buffer_load_ushort v124, v96, s[44:47], s40 offen offset:0
    buffer_load_ushort v125, v97, s[44:47], s40 offen offset:0
    buffer_load_ushort v126, v96, s[44:47], s40 offen offset:256
    buffer_load_ushort v127, v97, s[44:47], s40 offen offset:256
    buffer_load_ushort v128, v96, s[44:47], s40 offen offset:512
    buffer_load_ushort v129, v97, s[44:47], s40 offen offset:512
    buffer_load_ushort v130, v96, s[44:47], s40 offen offset:768
    buffer_load_ushort v131, v97, s[44:47], s40 offen offset:768
    s_add_u32 s40, s40, 4096
    s_waitcnt vmcnt(0)
    v_lshl_or_b32 v172, v125, 16, v124
    v_lshl_or_b32 v173, v127, 16, v126
    v_lshl_or_b32 v174, v129, 16, v128
    v_lshl_or_b32 v175, v131, 16, v130
    buffer_load_ushort v124, v96, s[44:47], s40 offen offset:0
    buffer_load_ushort v125, v97, s[44:47], s40 offen offset:0
    buffer_load_ushort v126, v96, s[44:47], s40 offen offset:256
    buffer_load_ushort v127, v97, s[44:47], s40 offen offset:256
    buffer_load_ushort v128, v96, s[44:47], s40 offen offset:512
    buffer_load_ushort v129, v97, s[44:47], s40 offen offset:512
    buffer_load_ushort v130, v96, s[44:47], s40 offen offset:768
    buffer_load_ushort v131, v97, s[44:47], s40 offen offset:768
    s_add_u32 s40, s40, 12288
    s_waitcnt vmcnt(0)
    v_lshl_or_b32 v176, v125, 16, v124
    v_lshl_or_b32 v177, v127, 16, v126
    v_lshl_or_b32 v178, v129, 16, v128
    v_lshl_or_b32 v179, v131, 16, v130
    buffer_load_ushort v124, v96, s[44:47], s40 offen offset:0
    buffer_load_ushort v125, v97, s[44:47], s40 offen offset:0
    buffer_load_ushort v126, v96, s[44:47], s40 offen offset:256
    buffer_load_ushort v127, v97, s[44:47], s40 offen offset:256
    buffer_load_ushort v128, v96, s[44:47], s40 offen offset:512
    buffer_load_ushort v129, v97, s[44:47], s40 offen offset:512
    buffer_load_ushort v130, v96, s[44:47], s40 offen offset:768
    buffer_load_ushort v131, v97, s[44:47], s40 offen offset:768
    s_add_u32 s40, s40, 4096
    s_waitcnt vmcnt(0)
    v_lshl_or_b32 v180, v125, 16, v124
    v_lshl_or_b32 v181, v127, 16, v126
    v_lshl_or_b32 v182, v129, 16, v128
    v_lshl_or_b32 v183, v131, 16, v130
    buffer_load_ushort v124, v96, s[44:47], s40 offen offset:0
    buffer_load_ushort v125, v97, s[44:47], s40 offen offset:0
    buffer_load_ushort v126, v96, s[44:47], s40 offen offset:256
    buffer_load_ushort v127, v97, s[44:47], s40 offen offset:256
    buffer_load_ushort v128, v96, s[44:47], s40 offen offset:512
    buffer_load_ushort v129, v97, s[44:47], s40 offen offset:512
    buffer_load_ushort v130, v96, s[44:47], s40 offen offset:768
    buffer_load_ushort v131, v97, s[44:47], s40 offen offset:768
    s_add_u32 s40, s40, 12288
    s_waitcnt vmcnt(0)
    v_lshl_or_b32 v184, v125, 16, v124
    v_lshl_or_b32 v185, v127, 16, v126
    v_lshl_or_b32 v186, v129, 16, v128
    v_lshl_or_b32 v187, v131, 16, v130
    v_lshlrev_b32 v96, 3, v2
    buffer_load_dwordx2 v[118:119], v96, s[52:55], 0 offen
    v_mov_b32 v72, 0
    v_mov_b32 v73, 0
    v_mov_b32 v74, 0
    v_mov_b32 v75, 0
    s_mul_i32 s40, s22, 1552
    s_add_u32 s40, s40, 35760
    v_add_u32 v97, s40, v1
    ds_write_b128 v97, v[72:75] offset:0
    ds_write_b128 v97, v[72:75] offset:12416
    ds_write_b128 v97, v[72:75] offset:24832
    ds_write_b128 v97, v[72:75] offset:37248
    ds_write_b128 v97, v[72:75] offset:49664
    v_lshlrev_b32 v98, 2, v2
    ds_write_b32 v98, v72 offset:17536
    v_mul_u32_u24 v97, 20, v6
    v_add_u32 v97, v97, v5
    v_mul_u32_u24 v97, 1552, v97
    v_add_u32 v97, 35760, v97
    ds_write_b32 v98, v97 offset:17280
    s_mov_b32 s50, 0xbfb8aa3b
    s_waitcnt vmcnt(0) lgkmcnt(0)
    s_barrier
    v_lshlrev_b32 v120, 16, v118
    v_and_b32 v121, 0xffff0000, v118
    v_lshlrev_b32 v122, 16, v119
    v_and_b32 v123, 0xffff0000, v119
    s_mul_i32 s64, s2, 40
    s_lshl_b32 s65, s22, 8
    v_mov_b32 v100, 1
    v_and_b32 v99, 7, v2
    v_lshlrev_b32 v99, 5, v99
    v_lshl_add_u32 v99, v3, 8, v99
    v_bfe_u32 v104, v2, 3, 1
    v_lshl_add_u32 v99, v104, 2, v99
L_s_blk:
    buffer_load_dword v101, v98, s[56:59], s65 offen
    buffer_load_dword v102, v98, s[60:63], s65 offen
    s_waitcnt vmcnt(0)
    v_subrev_u32 v101, s64, v101
    v_cmp_gt_u32 s[66:67], 40, v101
    s_nop 3
L_s_edge:
    s_cmp_eq_u64 s[66:67], 0
    s_cbranch_scc1 L_s_next
    s_ff1_i32_b64 s68, s[66:67]
    s_bitset0_b64 s[66:67], s68
    v_readlane_b32 s69, v101, s68
    v_readlane_b32 s70, v102, s68
    v_mov_b32 v108, v120
    v_mov_b32 v109, v121
    v_mov_b32 v110, v122
    v_mov_b32 v111, v123
    s_lshl_b32 s71, s68, 5
    s_lshl_b32 s72, s65, 3
    s_add_u32 s71, s71, s72
    s_lshl_b32 s70, s70, 8
    s_add_u32 s72, s69, s64
    s_lshl_b32 s72, s72, 8
    s_sub_u32 s72, s72, 256
    s_mov_b32 s40, 0
L_s_chunk:
    s_lshl_b32 s41, s40, 5
    s_cmp_lt_u32 s40, 8
    s_cselect_b32 s42, s70, s72
    s_add_u32 s42, s42, s41
    s_cmp_lt_u32 s40, 16
    s_cselect_b32 s42, s42, s71
    s_cselect_b32 s48, s4, s6
    s_cselect_b32 s49, s5, s7
    s_load_dwordx8 s[88:95], s[48:49], s42
    s_lshl_b32 s41, s40, 13
    s_add_u32 s43, s41, 4096
    buffer_load_dwordx2 v[124:125], v96, s[36:39], s41 offen offset:0
    buffer_load_dwordx2 v[126:127], v96, s[36:39], s41 offen offset:512
    buffer_load_dwordx2 v[128:129], v96, s[36:39], s41 offen offset:1024
    buffer_load_dwordx2 v[130:131], v96, s[36:39], s41 offen offset:1536
    buffer_load_dwordx2 v[132:133], v96, s[36:39], s41 offen offset:2048
    buffer_load_dwordx2 v[134:135], v96, s[36:39], s41 offen offset:2560
    buffer_load_dwordx2 v[136:137], v96, s[36:39], s41 offen offset:3072
    buffer_load_dwordx2 v[138:139], v96, s[36:39], s41 offen offset:3584
    buffer_load_dwordx2 v[140:141], v96, s[36:39], s43 offen offset:0
    buffer_load_dwordx2 v[142:143], v96, s[36:39], s43 offen offset:512
    buffer_load_dwordx2 v[144:145], v96, s[36:39], s43 offen offset:1024
    buffer_load_dwordx2 v[146:147], v96, s[36:39], s43 offen offset:1536
    buffer_load_dwordx2 v[148:149], v96, s[36:39], s43 offen offset:2048
    buffer_load_dwordx2 v[150:151], v96, s[36:39], s43 offen offset:2560
    buffer_load_dwordx2 v[152:153], v96, s[36:39], s43 offen offset:3072
    buffer_load_dwordx2 v[154:155], v96, s[36:39], s43 offen offset:3584
    s_waitcnt vmcnt(0) lgkmcnt(0)
    s_lshl_b32 s42, s88, 16
    v_lshlrev_b32 v112, 16, v124
    v_and_b32 v113, 0xffff0000, v124
    v_fmac_f32 v108, s42, v112
    v_fmac_f32 v109, s42, v113
    v_lshlrev_b32 v112, 16, v125
    v_and_b32 v113, 0xffff0000, v125
    v_fmac_f32 v110, s42, v112
    v_fmac_f32 v111, s42, v113
    s_and_b32 s42, s88, 0xffff0000
    v_lshlrev_b32 v112, 16, v126
    v_and_b32 v113, 0xffff0000, v126
    v_fmac_f32 v108, s42, v112
    v_fmac_f32 v109, s42, v113
    v_lshlrev_b32 v112, 16, v127
    v_and_b32 v113, 0xffff0000, v127
    v_fmac_f32 v110, s42, v112
    v_fmac_f32 v111, s42, v113
    s_lshl_b32 s42, s89, 16
    v_lshlrev_b32 v112, 16, v128
    v_and_b32 v113, 0xffff0000, v128
    v_fmac_f32 v108, s42, v112
    v_fmac_f32 v109, s42, v113
    v_lshlrev_b32 v112, 16, v129
    v_and_b32 v113, 0xffff0000, v129
    v_fmac_f32 v110, s42, v112
    v_fmac_f32 v111, s42, v113
    s_and_b32 s42, s89, 0xffff0000
    v_lshlrev_b32 v112, 16, v130
    v_and_b32 v113, 0xffff0000, v130
    v_fmac_f32 v108, s42, v112
    v_fmac_f32 v109, s42, v113
    v_lshlrev_b32 v112, 16, v131
    v_and_b32 v113, 0xffff0000, v131
    v_fmac_f32 v110, s42, v112
    v_fmac_f32 v111, s42, v113
    s_lshl_b32 s42, s90, 16
    v_lshlrev_b32 v112, 16, v132
    v_and_b32 v113, 0xffff0000, v132
    v_fmac_f32 v108, s42, v112
    v_fmac_f32 v109, s42, v113
    v_lshlrev_b32 v112, 16, v133
    v_and_b32 v113, 0xffff0000, v133
    v_fmac_f32 v110, s42, v112
    v_fmac_f32 v111, s42, v113
    s_and_b32 s42, s90, 0xffff0000
    v_lshlrev_b32 v112, 16, v134
    v_and_b32 v113, 0xffff0000, v134
    v_fmac_f32 v108, s42, v112
    v_fmac_f32 v109, s42, v113
    v_lshlrev_b32 v112, 16, v135
    v_and_b32 v113, 0xffff0000, v135
    v_fmac_f32 v110, s42, v112
    v_fmac_f32 v111, s42, v113
    s_lshl_b32 s42, s91, 16
    v_lshlrev_b32 v112, 16, v136
    v_and_b32 v113, 0xffff0000, v136
    v_fmac_f32 v108, s42, v112
    v_fmac_f32 v109, s42, v113
    v_lshlrev_b32 v112, 16, v137
    v_and_b32 v113, 0xffff0000, v137
    v_fmac_f32 v110, s42, v112
    v_fmac_f32 v111, s42, v113
    s_and_b32 s42, s91, 0xffff0000
    v_lshlrev_b32 v112, 16, v138
    v_and_b32 v113, 0xffff0000, v138
    v_fmac_f32 v108, s42, v112
    v_fmac_f32 v109, s42, v113
    v_lshlrev_b32 v112, 16, v139
    v_and_b32 v113, 0xffff0000, v139
    v_fmac_f32 v110, s42, v112
    v_fmac_f32 v111, s42, v113
    s_lshl_b32 s42, s92, 16
    v_lshlrev_b32 v112, 16, v140
    v_and_b32 v113, 0xffff0000, v140
    v_fmac_f32 v108, s42, v112
    v_fmac_f32 v109, s42, v113
    v_lshlrev_b32 v112, 16, v141
    v_and_b32 v113, 0xffff0000, v141
    v_fmac_f32 v110, s42, v112
    v_fmac_f32 v111, s42, v113
    s_and_b32 s42, s92, 0xffff0000
    v_lshlrev_b32 v112, 16, v142
    v_and_b32 v113, 0xffff0000, v142
    v_fmac_f32 v108, s42, v112
    v_fmac_f32 v109, s42, v113
    v_lshlrev_b32 v112, 16, v143
    v_and_b32 v113, 0xffff0000, v143
    v_fmac_f32 v110, s42, v112
    v_fmac_f32 v111, s42, v113
    s_lshl_b32 s42, s93, 16
    v_lshlrev_b32 v112, 16, v144
    v_and_b32 v113, 0xffff0000, v144
    v_fmac_f32 v108, s42, v112
    v_fmac_f32 v109, s42, v113
    v_lshlrev_b32 v112, 16, v145
    v_and_b32 v113, 0xffff0000, v145
    v_fmac_f32 v110, s42, v112
    v_fmac_f32 v111, s42, v113
    s_and_b32 s42, s93, 0xffff0000
    v_lshlrev_b32 v112, 16, v146
    v_and_b32 v113, 0xffff0000, v146
    v_fmac_f32 v108, s42, v112
    v_fmac_f32 v109, s42, v113
    v_lshlrev_b32 v112, 16, v147
    v_and_b32 v113, 0xffff0000, v147
    v_fmac_f32 v110, s42, v112
    v_fmac_f32 v111, s42, v113
    s_lshl_b32 s42, s94, 16
    v_lshlrev_b32 v112, 16, v148
    v_and_b32 v113, 0xffff0000, v148
    v_fmac_f32 v108, s42, v112
    v_fmac_f32 v109, s42, v113
    v_lshlrev_b32 v112, 16, v149
    v_and_b32 v113, 0xffff0000, v149
    v_fmac_f32 v110, s42, v112
    v_fmac_f32 v111, s42, v113
    s_and_b32 s42, s94, 0xffff0000
    v_lshlrev_b32 v112, 16, v150
    v_and_b32 v113, 0xffff0000, v150
    v_fmac_f32 v108, s42, v112
    v_fmac_f32 v109, s42, v113
    v_lshlrev_b32 v112, 16, v151
    v_and_b32 v113, 0xffff0000, v151
    v_fmac_f32 v110, s42, v112
    v_fmac_f32 v111, s42, v113
    s_lshl_b32 s42, s95, 16
    v_lshlrev_b32 v112, 16, v152
    v_and_b32 v113, 0xffff0000, v152
    v_fmac_f32 v108, s42, v112
    v_fmac_f32 v109, s42, v113
    v_lshlrev_b32 v112, 16, v153
    v_and_b32 v113, 0xffff0000, v153
    v_fmac_f32 v110, s42, v112
    v_fmac_f32 v111, s42, v113
    s_and_b32 s42, s95, 0xffff0000
    v_lshlrev_b32 v112, 16, v154
    v_and_b32 v113, 0xffff0000, v154
    v_fmac_f32 v108, s42, v112
    v_fmac_f32 v109, s42, v113
    v_lshlrev_b32 v112, 16, v155
    v_and_b32 v113, 0xffff0000, v155
    v_fmac_f32 v110, s42, v112
    v_fmac_f32 v111, s42, v113
    s_add_u32 s40, s40, 1
    s_cmp_lt_u32 s40, 17
    s_cbranch_scc1 L_s_chunk
    s_mul_i32 s72, s69, 1552
    s_add_u32 s72, s72, 35760
    v_add_u32 v103, s72, v99
    s_lshl_b32 s69, s69, 2
    v_mov_b32 v116, s69
    v_mul_f32 v108, s50, v108
    v_mul_f32 v109, s50, v109
    v_mul_f32 v110, s50, v110
    v_mul_f32 v111, s50, v111
    v_exp_f32 v112, v108
    v_exp_f32 v113, v109
    v_exp_f32 v114, v110
    v_exp_f32 v115, v111
    s_nop 0
    v_add_f32 v112, 1.0, v112
    v_add_f32 v113, 1.0, v113
    v_add_f32 v114, 1.0, v114
    v_add_f32 v115, 1.0, v115
    v_rcp_f32 v112, v112
    v_rcp_f32 v113, v113
    v_rcp_f32 v114, v114
    v_rcp_f32 v115, v115
    s_nop 0
    v_mul_f32 v108, v108, v112
    ds_add_f32 v103, v108 offset:0
    v_mul_f32 v109, v109, v113
    ds_add_f32 v103, v109 offset:8
    v_mul_f32 v110, v110, v114
    ds_add_f32 v103, v110 offset:16
    v_mul_f32 v111, v111, v115
    ds_add_f32 v103, v111 offset:24
    s_mov_b64 exec, 1
    ds_add_u32 v116, v100 offset:17536
    s_mov_b64 exec, -1
    s_branch L_s_edge
L_s_next:
    s_add_u32 s65, s65, 2048
    s_cmp_lt_u32 s65, 1280000
    s_cbranch_scc1 L_s_blk
    s_mov_b32 s56, s18
    s_mov_b32 s57, s19
    s_mov_b32 s58, 256
    s_mov_b32 s59, 0x00020000
    s_lshl_b32 s40, s22, 5
    v_lshlrev_b32 v96, 3, v3
    buffer_load_dwordx2 v[98:99], v96, s[56:59], s40 offen
    s_waitcnt vmcnt(0) lgkmcnt(0)
    s_barrier
    s_lshl_b32 s45, s27, 7
    v_lshl_add_u32 v198, v3, 2, s45
    v_lshlrev_b32 v199, 2, v4
    ds_read_b32 v218, v198 offset:17280
    ds_read_b32 v219, v198 offset:17296
    ds_read_b32 v220, v198 offset:17312
    ds_read_b32 v221, v198 offset:17328
    ds_read_b32 v222, v198 offset:17344
    ds_read_b32 v223, v199 offset:17536
    ds_read_b32 v224, v199 offset:17600
    ds_read_b32 v225, v199 offset:17664
    v_lshlrev_b32 v246, 16, v98
    v_and_b32 v247, 0xffff0000, v98
    v_lshlrev_b32 v248, 16, v99
    v_and_b32 v249, 0xffff0000, v99
    s_lshl_b32 s45, s26, 8
    v_lshl_add_u32 v198, v4, 4, s45
    v_lshrrev_b32 v199, 1, v198
    s_mov_b32 s45, 0xbfb8aa3b
    s_waitcnt lgkmcnt(0)
    v_add_u32 v201, v218, v198
    v_add_u32 v218, v218, v199
    v_add_u32 v202, v219, v198
    v_add_u32 v219, v219, v199
    v_add_u32 v203, v220, v198
    v_add_u32 v220, v220, v199
    v_add_u32 v204, v221, v198
    v_add_u32 v221, v221, v199
    v_add_u32 v205, v222, v198
    v_add_u32 v222, v222, v199
    v_cvt_f32_u32 v223, v223
    v_mul_f32 v223, s45, v223
    v_cvt_f32_u32 v224, v224
    v_mul_f32 v224, s45, v224
    v_cvt_f32_u32 v225, v225
    v_mul_f32 v225, s45, v225
    v_mul_f32 v234, v223, v246
    v_mul_f32 v235, v223, v247
    v_mul_f32 v236, v223, v248
    v_mul_f32 v237, v223, v249
    v_mul_f32 v238, v224, v246
    v_mul_f32 v239, v224, v247
    v_mul_f32 v240, v224, v248
    v_mul_f32 v241, v224, v249
    v_mul_f32 v242, v225, v246
    v_mul_f32 v243, v225, v247
    v_mul_f32 v244, v225, v248
    v_mul_f32 v245, v225, v249
    s_branch L_havew2
.section .rodata,"a"
.p2align 6
.amdhsa_kernel standalone__edge_featured_mpnn_mpnn__graph_kernel
  .amdhsa_next_free_vgpr 256
  .amdhsa_next_free_sgpr 102
  .amdhsa_accum_offset 256
  .amdhsa_group_segment_fixed_size 0
  .amdhsa_kernarg_size 88
  .amdhsa_user_sgpr_count 2
  .amdhsa_user_sgpr_kernarg_segment_ptr 1
  .amdhsa_system_sgpr_workgroup_id_x 1
  .amdhsa_float_denorm_mode_32 3
.end_amdhsa_kernel
```
